```python
import torch

def _softmax(x, axis=-1):
    return torch.softmax(x, dim=axis)
def _gelu(x):
    return torch.nn.functional.gelu(x, approximate="tanh")
def _silu(x):
    return torch.nn.functional.silu(x)
def _sigmoid(x):
    return torch.sigmoid(x)
def _layernorm(x, axis=-1, eps=1e-5):
    m = x.mean(dim=axis, keepdim=True)
    v = x.var(dim=axis, keepdim=True, unbiased=False)
    return (x - m) / torch.sqrt(v + eps)
def _scatter_add(tgt, idx, src, axis=0):
    return tgt.clone().index_add_(axis, idx, src)
def _segment_sum(src, seg, n):
    out = torch.zeros((n,) + src.shape[1:], dtype=src.dtype)
    return out.index_add_(0, seg, src)
def _pad(x, pw):
    flat = tuple(v for pair in reversed(pw) for v in pair)
    return torch.nn.functional.pad(x, flat)

kernel_name = 'concat_heads__gqa_block_cached__gqa_block_cached__near_ridge'

def setup_inputs():

    _w = (lambda a: (lambda t: t.to(torch.bfloat16) if t.is_floating_point() else t)(torch.as_tensor(a)))
    def _A_setup():
        B, Sq, D = 8, 160, 512
        Hq, Hkv, Sk, Dh = 32, 32, 512, 128
        assert Hq % Hkv == 0, (Hq, Hkv)
        return {
            "x": _w((lambda *s: torch.randn(*s, dtype=torch.bfloat16) * 0.8)(B, Sq, D)),
            "k_cache": _w((lambda *s: torch.randn(*s, dtype=torch.bfloat16) * 0.8)(B, Hkv, Sk, Dh)),
            "v_cache": _w((lambda *s: torch.randn(*s, dtype=torch.bfloat16) * 0.05)(B, Hkv, Sk, Dh)),
            "wq": _w((lambda *s: torch.randn(*s, dtype=torch.bfloat16) * 0.8)(D, Hq * Dh) * (D ** -0.5)),
            "wo": _w((lambda *s: torch.randn(*s, dtype=torch.bfloat16) * 0.05)(Hq * Dh, D) * ((Hq * Dh) ** -0.5)),
        }
    _A_in = _A_setup()

    def _B_setup():
        B, Sq, D = 8, 160, 512
        Hq, Hkv, Sk, Dh = 32, 32, 512, 128
        assert Hq % Hkv == 0, (Hq, Hkv)
        return {
            "x": _w((lambda *s: torch.randn(*s, dtype=torch.bfloat16) * 0.8)(B, Sq, D)),
            "k_cache": _w((lambda *s: torch.randn(*s, dtype=torch.bfloat16) * 0.8)(B, Hkv, Sk, Dh)),
            "v_cache": _w((lambda *s: torch.randn(*s, dtype=torch.bfloat16) * 0.05)(B, Hkv, Sk, Dh)),
            "wq": _w((lambda *s: torch.randn(*s, dtype=torch.bfloat16) * 0.8)(D, Hq * Dh) * (D ** -0.5)),
            "wo": _w((lambda *s: torch.randn(*s, dtype=torch.bfloat16) * 0.05)(Hq * Dh, D) * ((Hq * Dh) ** -0.5)),
        }
    _B_in = _B_setup()

    return {
        "A_x": _A_in["x"],
        "A_k_cache": _A_in["k_cache"],
        "A_v_cache": _A_in["v_cache"],
        "A_wq": _A_in["wq"],
        "A_wo": _A_in["wo"],
        "B_x": _B_in["x"],
        "B_k_cache": _B_in["k_cache"],
        "B_v_cache": _B_in["v_cache"],
        "B_wq": _B_in["wq"],
        "B_wo": _B_in["wo"],
    }

def reference(A_x, A_k_cache, A_v_cache, A_wq, A_wo, B_x, B_k_cache, B_v_cache, B_wq, B_wo):
    def _A_ref(x, k_cache, v_cache, wq, wo):
        B, Sq, D = x.shape
        Hq, Dh = 32, 128
        Hkv = k_cache.shape[1]
        rep = Hq // Hkv
        q = (lambda x, *d: x.permute(*d))((x @ wq).reshape(B, Sq, Hq, Dh), 0, 2, 1, 3)
        k = (lambda x, n, axis: torch.repeat_interleave(x, n, dim=axis))(k_cache, rep, axis=1)
        v = (lambda x, n, axis: torch.repeat_interleave(x, n, dim=axis))(v_cache, rep, axis=1)
        scores = torch.einsum("bhqd,bhkd->bhqk", q, k) * (Dh ** -0.5)
        p = _softmax(scores, axis=-1)
        o = torch.einsum("bhqk,bhkd->bhqd", p, v)
        return (lambda x, *d: x.permute(*d))(o, 0, 2, 1, 3).reshape(B, Sq, Hq * Dh) @ wo

    def _B_ref(x, k_cache, v_cache, wq, wo):
        B, Sq, D = x.shape
        Hq, Dh = 32, 128
        Hkv = k_cache.shape[1]
        rep = Hq // Hkv
        q = (lambda x, *d: x.permute(*d))((x @ wq).reshape(B, Sq, Hq, Dh), 0, 2, 1, 3)
        k = (lambda x, n, axis: torch.repeat_interleave(x, n, dim=axis))(k_cache, rep, axis=1)
        v = (lambda x, n, axis: torch.repeat_interleave(x, n, dim=axis))(v_cache, rep, axis=1)
        scores = torch.einsum("bhqd,bhkd->bhqk", q, k) * (Dh ** -0.5)
        p = _softmax(scores, axis=-1)
        o = torch.einsum("bhqk,bhkd->bhqd", p, v)
        return (lambda x, *d: x.permute(*d))(o, 0, 2, 1, 3).reshape(B, Sq, Hq * Dh) @ wo

    a = _A_ref(A_x, A_k_cache, A_v_cache, A_wq, A_wo)
    b = _B_ref(B_x, B_k_cache, B_v_cache, B_wq, B_wo)
    return torch.concatenate([a, b], axis=-1)
```

```asm
; @launch grid=(256,1,1) block=(640,1,1) lds=163840
.amdgcn_target "amdgcn-amd-amdhsa--gfx950"
.text
.globl concat_heads__gqa_block_cached__gqa_block_cached__near_ridge_kernel
.p2align 8
.type concat_heads__gqa_block_cached__gqa_block_cached__near_ridge_kernel,@function
concat_heads__gqa_block_cached__gqa_block_cached__near_ridge_kernel:
  s_cmp_ge_u32 s2, 256
  s_cbranch_scc1 concat_heads__gqa_block_cached__gqa_block_cached__near_ridge_kernel_end
  s_load_dwordx2 s[56:57], s[0:1], 96
  s_load_dwordx2 s[6:7], s[0:1], 80
  s_load_dwordx2 s[96:97], s[0:1], 88
  s_and_b32 s35, s2, 7
  s_lshr_b32 s36, s2, 3
  s_lshr_b32 s45, s35, 2
  s_mul_i32 s37, s45, 40
  s_add_u32 s0, s0, s37
  s_addc_u32 s1, s1, 0
  s_load_dwordx8 s[48:55], s[0:1], 0
  s_load_dwordx2 s[62:63], s[0:1], 32
  s_and_b32 s35, s35, 3
  s_lshr_b32 s46, s36, 2
  s_and_b32 s36, s36, 3
  s_mov_b32 s100, s36
  s_lshl_b32 s35, s35, 2
  s_add_u32 s44, s35, s36
  s_lshl_b32 s44, s44, 1
  v_lshrrev_b32 v1, 6, v0
  v_and_b32 v162, 63, v0
  v_readfirstlane_b32 s28, v1
  s_and_b32 s29, s28, 1
  s_lshr_b32 s30, s28, 1
  s_and_b32 s35, s28, 3
  s_lshl_b32 s32, s35, 10
  s_cmp_lt_u32 s28, 8
  s_cbranch_scc1 concat_heads__gqa_block_cached__gqa_block_cached__near_ridge_kernel_noct
  s_lshr_b32 s36, s2, 3
  s_cmp_ge_u32 s36, 2
  s_cbranch_scc1 concat_heads__gqa_block_cached__gqa_block_cached__near_ridge_kernel_noct
  s_getpc_b64 s[60:61]
concat_heads__gqa_block_cached__gqa_block_cached__near_ridge_kernel_pc:
  s_lshl_b32 s36, s36, 1
  s_add_u32 s36, s36, s29
  s_lshl_b32 s36, s36, 13
  v_lshlrev_b32 v2, 7, v162
  v_add_u32 v2, s36, v2
  s_mov_b32 s36, concat_heads__gqa_block_cached__gqa_block_cached__near_ridge_kernel_end-concat_heads__gqa_block_cached__gqa_block_cached__near_ridge_kernel_pc
  v_cmp_gt_u32 vcc, s36, v2
  s_and_saveexec_b64 s[4:5], vcc
  s_cbranch_execz concat_heads__gqa_block_cached__gqa_block_cached__near_ridge_kernel_ct2
  global_load_dword v165, v2, s[60:61]
concat_heads__gqa_block_cached__gqa_block_cached__near_ridge_kernel_ct2:
  s_mov_b64 exec, -1
concat_heads__gqa_block_cached__gqa_block_cached__near_ridge_kernel_noct:
  v_lshrrev_b32 v2, 4, v162
  v_lshlrev_b32 v3, 2, v2
  v_and_b32 v4, 15, v162
  v_xor_b32 v3, v3, v4
  v_lshlrev_b32 v3, 4, v3
  v_lshl_add_u32 v157, v2, 8, v3
  v_lshl_add_u32 v159, v2, 13, v3
  v_and_b32 v2, 3, v2
  v_and_b32 v4, 3, v162
  v_xor_b32 v2, v2, v4
  v_lshlrev_b32 v2, 4, v2
  v_lshrrev_b32 v3, 2, v162
  v_lshl_add_u32 v158, v3, 10, v2
  s_lshl_b32 s36, s35, 3
  v_lshrrev_b32 v2, 3, v162
  v_add_u32 v2, s36, v2
  v_bfe_u32 v3, v2, 1, 3
  v_and_b32 v4, 7, v162
  v_xor_b32 v3, v3, v4
  v_lshlrev_b32 v3, 4, v3
  v_lshl_add_u32 v156, v2, 8, v3
  s_lshl_b32 s40, s29, 13
  s_lshl_b32 s31, s29, 8
  s_mul_i32 s42, s29, 81920
  s_mul_i32 s43, s29, 5120
  s_mul_i32 s3, s46, 2
  s_mul_i32 s36, s100, 0
  s_add_u32 s3, s3, s36
  s_and_b32 s3, s3, 15
  s_lshr_b32 s58, s2, 3
  s_and_b32 s36, s2, 7
  s_mul_i32 s36, s36, 2
  s_mul_i32 s58, s58, 1
  s_add_u32 s58, s58, s36
  s_and_b32 s58, s58, 15
  s_lshl_b32 s58, s58, 13
  s_waitcnt lgkmcnt(0)
  s_mov_b32 s98, 256
  s_mov_b32 s99, 0x00020000
  s_cmp_eq_u32 s28, 0
  s_cbranch_scc0 concat_heads__gqa_block_cached__gqa_block_cached__near_ridge_kernel_noinit
  s_mov_b32 s35, 34603008
  s_add_u32 s8, s56, s35
  s_addc_u32 s9, s57, 0
  s_mov_b32 s10, 65536
  s_mov_b32 s11, 0x00020000
  s_lshl_b32 s35, s2, 8
  v_lshlrev_b32 v2, 6, v162
  v_add_u32 v2, s35, v2
  v_mov_b32 v3, 0
  s_mov_b64 exec, 15
  buffer_store_dword v3, v2, s[8:11], 0 offen sc1
  s_waitcnt vmcnt(0)
  s_lshl_b32 s35, s45, 3
  s_add_u32 s35, s35, s46
  s_lshl_b32 s35, s35, 2
  s_mov_b64 exec, 1
  v_mov_b32 v2, s35
  v_mov_b32 v3, 1
  buffer_atomic_add v3, v2, s[96:99], 0 offen sc1
  s_mov_b64 exec, -1
concat_heads__gqa_block_cached__gqa_block_cached__near_ridge_kernel_noinit:
  s_mul_i32 s35, s46, 163840
  s_add_u32 s8, s48, s35
  s_addc_u32 s9, s49, 0
  s_mov_b32 s10, 163840
  s_mov_b32 s11, 0x00020000
  s_lshl_b32 s35, s44, 8
  s_add_u32 s12, s54, s35
  s_addc_u32 s13, s55, 0
  s_mov_b32 s14, 0
  s_mov_b32 s15, 0x00020000
  s_sub_u32 s14, 4194304, s35
  s_lshl_b32 s35, s46, 5
  s_add_u32 s35, s35, s44
  s_lshl_b32 s35, s35, 17
  s_add_u32 s16, s50, s35
  s_addc_u32 s17, s51, 0
  s_mov_b32 s18, 262144
  s_mov_b32 s19, 0x00020000
  s_add_u32 s20, s52, s35
  s_addc_u32 s21, s53, 0
  s_mov_b32 s22, 262144
  s_mov_b32 s23, 0x00020000
  s_lshl_b32 s35, s45, 3
  s_add_u32 s35, s35, s46
  s_mul_i32 s35, s35, 1310720
  s_add_u32 s24, s56, s35
  s_addc_u32 s25, s57, 0
  s_mov_b32 s26, 1310720
  s_mov_b32 s27, 0x00020000
  s_cmp_eq_u32 s30, 1
  s_cbranch_scc1 concat_heads__gqa_block_cached__gqa_block_cached__near_ridge_kernel_cls1
  s_cmp_eq_u32 s30, 2
  s_cbranch_scc1 concat_heads__gqa_block_cached__gqa_block_cached__near_ridge_kernel_cls2
  s_cmp_eq_u32 s30, 3
  s_cbranch_scc1 concat_heads__gqa_block_cached__gqa_block_cached__near_ridge_kernel_cls3
  s_cmp_eq_u32 s30, 4
  s_cbranch_scc1 concat_heads__gqa_block_cached__gqa_block_cached__near_ridge_kernel_cls4
concat_heads__gqa_block_cached__gqa_block_cached__near_ridge_kernel_cls0:
  s_add_u32 s3, s3, 1
  s_and_b32 s3, s3, 15
  s_add_u32 s3, s3, 1
  s_and_b32 s3, s3, 15
  s_add_u32 s3, s3, 1
  s_and_b32 s3, s3, 15
  v_lshrrev_b32 v1, 5, v162
  v_bfe_u32 v2, v162, 2, 2
  v_lshl_add_u32 v3, v1, 3, v2
  v_lshlrev_b32 v3, 8, v3
  v_lshl_add_u32 v3, v2, 6, v3
  v_bfe_u32 v4, v162, 4, 1
  v_lshl_add_u32 v3, v4, 5, v3
  v_and_b32 v4, 1, v162
  v_lshl_add_u32 v3, v4, 4, v3
  v_bfe_u32 v4, v162, 1, 1
  v_lshl_add_u32 v3, v4, 3, v3
  s_add_u32 s36, s40, 16384
  v_add_u32 v149, s36, v3
  v_and_b32 v2, 0x13, v162
  v_and_b32 v3, 4, v162
  v_lshl_or_b32 v2, v3, 1, v2
  v_and_b32 v3, 8, v162
  v_lshrrev_b32 v3, 1, v3
  v_or_b32 v2, v2, v3
  v_bfe_u32 v3, v2, 1, 3
  v_xor_b32 v3, v3, v1
  v_lshlrev_b32 v3, 4, v3
  v_lshl_add_u32 v3, v2, 7, v3
  v_add_u32 v148, s40, v3
  v_and_b32 v2, 31, v162
  v_bfe_u32 v3, v162, 2, 2
  v_xor_b32 v3, v3, v1
  v_lshlrev_b32 v3, 4, v3
  v_lshl_add_u32 v3, v2, 6, v3
  s_lshl_b32 s35, s30, 11
  v_add_u32 v160, s35, v3
  v_lshlrev_b32 v161, 4, v162
  v_mov_b32 v0, 0
  v_mov_b32 v1, 0
  v_mov_b32 v2, 0
  v_mov_b32 v3, 0
  v_mov_b32 v4, 0
  v_mov_b32 v5, 0
  v_mov_b32 v6, 0
  v_mov_b32 v7, 0
  v_mov_b32 v8, 0
  v_mov_b32 v9, 0
  v_mov_b32 v10, 0
  v_mov_b32 v11, 0
  v_mov_b32 v12, 0
  v_mov_b32 v13, 0
  v_mov_b32 v14, 0
  v_mov_b32 v15, 0
  v_mov_b32 v16, 0
  v_mov_b32 v17, 0
  v_mov_b32 v18, 0
  v_mov_b32 v19, 0
  v_mov_b32 v20, 0
  v_mov_b32 v21, 0
  v_mov_b32 v22, 0
  v_mov_b32 v23, 0
  v_mov_b32 v24, 0
  v_mov_b32 v25, 0
  v_mov_b32 v26, 0
  v_mov_b32 v27, 0
  v_mov_b32 v28, 0
  v_mov_b32 v29, 0
  v_mov_b32 v30, 0
  v_mov_b32 v31, 0
  v_mov_b32 v32, 0
  v_mov_b32 v33, 0
  v_mov_b32 v34, 0
  v_mov_b32 v35, 0
  v_mov_b32 v36, 0
  v_mov_b32 v37, 0
  v_mov_b32 v38, 0
  v_mov_b32 v39, 0
  v_mov_b32 v40, 0
  v_mov_b32 v41, 0
  v_mov_b32 v42, 0
  v_mov_b32 v43, 0
  v_mov_b32 v44, 0
  v_mov_b32 v45, 0
  v_mov_b32 v46, 0
  v_mov_b32 v47, 0
  v_mov_b32 v48, 0
  v_mov_b32 v49, 0
  v_mov_b32 v50, 0
  v_mov_b32 v51, 0
  v_mov_b32 v52, 0
  v_mov_b32 v53, 0
  v_mov_b32 v54, 0
  v_mov_b32 v55, 0
  v_mov_b32 v56, 0
  v_mov_b32 v57, 0
  v_mov_b32 v58, 0
  v_mov_b32 v59, 0
  v_mov_b32 v60, 0
  v_mov_b32 v61, 0
  v_mov_b32 v62, 0
  v_mov_b32 v63, 0
  s_barrier
  v_add_u32 v144, 124928, v149
  v_add_u32 v154, 131072, v160
  v_xor_b32 v145, 64, v144
  v_xor_b32 v146, 128, v144
  v_xor_b32 v147, 192, v144
  v_xor_b32 v155, 32, v154
  ds_read_b128 v[96:99], v154
  ds_read_b64_tr_b16 v[104:105], v144 offset:0
  ds_read_b64_tr_b16 v[106:107], v144 offset:1024
  ds_read_b64_tr_b16 v[108:109], v145 offset:0
  ds_read_b64_tr_b16 v[110:111], v145 offset:1024
  ds_read_b64_tr_b16 v[112:113], v146 offset:0
  ds_read_b64_tr_b16 v[114:115], v146 offset:1024
  ds_read_b64_tr_b16 v[116:117], v147 offset:0
  ds_read_b64_tr_b16 v[118:119], v147 offset:1024
  ds_read_b128 v[100:103], v155
  ds_read_b64_tr_b16 v[120:121], v144 offset:4096
  ds_read_b64_tr_b16 v[122:123], v144 offset:5120
  ds_read_b64_tr_b16 v[124:125], v145 offset:4096
  ds_read_b64_tr_b16 v[126:127], v145 offset:5120
  s_waitcnt lgkmcnt(8)
  ds_read_b64_tr_b16 v[128:129], v146 offset:4096
  ds_read_b64_tr_b16 v[130:131], v146 offset:5120
  ds_read_b64_tr_b16 v[132:133], v147 offset:4096
  ds_read_b64_tr_b16 v[134:135], v147 offset:5120
  s_waitcnt lgkmcnt(0)
  s_mov_b32 s59, 131072
  s_mov_b32 s61, 65536
  s_mov_b32 s39, 0
  s_mov_b32 s4, s58
  s_mov_b32 s5, 0
concat_heads__gqa_block_cached__gqa_block_cached__near_ridge_kernel_ql0:
  s_barrier
  s_add_u32 s37, s61, 4294961152
  v_add_u32 v144, s37, v149
  v_add_u32 v154, s61, v160
  v_xor_b32 v145, 64, v144
  v_xor_b32 v146, 128, v144
  v_xor_b32 v147, 192, v144
  v_xor_b32 v155, 32, v154
  v_mfma_f32_32x32x16_bf16 v[0:15], v[104:107], v[96:99], v[0:15]
  ds_read_b128 v[136:139], v154
  ds_read_b64_tr_b16 v[64:65], v144 offset:0
  ds_read_b64_tr_b16 v[66:67], v144 offset:1024
  v_mfma_f32_32x32x16_bf16 v[16:31], v[108:111], v[96:99], v[16:31]
  ds_read_b64_tr_b16 v[68:69], v145 offset:0
  ds_read_b64_tr_b16 v[70:71], v145 offset:1024
  ds_read_b64_tr_b16 v[72:73], v146 offset:0
  v_mfma_f32_32x32x16_bf16 v[32:47], v[112:115], v[96:99], v[32:47]
  ds_read_b64_tr_b16 v[74:75], v146 offset:1024
  ds_read_b64_tr_b16 v[76:77], v147 offset:0
  ds_read_b64_tr_b16 v[78:79], v147 offset:1024
  v_mfma_f32_32x32x16_bf16 v[48:63], v[116:119], v[96:99], v[48:63]
  ds_read_b128 v[140:143], v155
  ds_read_b64_tr_b16 v[80:81], v144 offset:4096
  ds_read_b64_tr_b16 v[82:83], v144 offset:5120
  v_mfma_f32_32x32x16_bf16 v[0:15], v[120:123], v[100:103], v[0:15]
  s_waitcnt lgkmcnt(9)
  ds_read_b64_tr_b16 v[84:85], v145 offset:4096
  ds_read_b64_tr_b16 v[86:87], v145 offset:5120
  ds_read_b64_tr_b16 v[88:89], v146 offset:4096
  v_mfma_f32_32x32x16_bf16 v[16:31], v[124:127], v[100:103], v[16:31]
  s_waitcnt lgkmcnt(9)
  ds_read_b64_tr_b16 v[90:91], v146 offset:5120
  ds_read_b64_tr_b16 v[92:93], v147 offset:4096
  ds_read_b64_tr_b16 v[94:95], v147 offset:5120
  v_mfma_f32_32x32x16_bf16 v[32:47], v[128:131], v[100:103], v[32:47]
  v_mfma_f32_32x32x16_bf16 v[48:63], v[132:135], v[100:103], v[48:63]
  s_add_u32 s3, s3, 1
  s_and_b32 s3, s3, 15
  s_mov_b32 s59, s61
  s_add_u32 s61, s61, 32768
  s_cmp_eq_u32 s61, 163840
  s_cselect_b32 s61, 65536, s61
  s_cmp_ge_u32 s39, 2
  s_cbranch_scc0 concat_heads__gqa_block_cached__gqa_block_cached__near_ridge_kernel_nokv1
  s_cmp_lt_u32 s39, 6
  s_cbranch_scc0 concat_heads__gqa_block_cached__gqa_block_cached__near_ridge_kernel_nokv1
  s_add_u32 s35, s5, s32
  s_add_u32 m0, s35, 0
  s_add_u32 s38, s4, 0
  buffer_load_dwordx4 v156, s[16:19], s38 offen nt lds
  s_add_u32 m0, s35, 4096
  s_add_u32 s38, s4, 128
  buffer_load_dwordx4 v156, s[16:19], s38 offen nt lds
  s_add_u32 m0, s35, 2048
  s_add_u32 s38, s4, 4096
  buffer_load_dwordx4 v156, s[16:19], s38 offen nt lds
  s_add_u32 m0, s35, 6144
  s_add_u32 s38, s4, 4224
  buffer_load_dwordx4 v156, s[16:19], s38 offen nt lds
concat_heads__gqa_block_cached__gqa_block_cached__near_ridge_kernel_nokv1:
  s_waitcnt lgkmcnt(0)
  s_barrier
  s_add_u32 s37, s61, 4294961152
  v_add_u32 v144, s37, v149
  v_add_u32 v154, s61, v160
  v_xor_b32 v145, 64, v144
  v_xor_b32 v146, 128, v144
  v_xor_b32 v147, 192, v144
  v_xor_b32 v155, 32, v154
  v_mfma_f32_32x32x16_bf16 v[0:15], v[64:67], v[136:139], v[0:15]
  ds_read_b128 v[96:99], v154
  ds_read_b64_tr_b16 v[104:105], v144 offset:0
  ds_read_b64_tr_b16 v[106:107], v144 offset:1024
  v_mfma_f32_32x32x16_bf16 v[16:31], v[68:71], v[136:139], v[16:31]
  ds_read_b64_tr_b16 v[108:109], v145 offset:0
  ds_read_b64_tr_b16 v[110:111], v145 offset:1024
  ds_read_b64_tr_b16 v[112:113], v146 offset:0
  v_mfma_f32_32x32x16_bf16 v[32:47], v[72:75], v[136:139], v[32:47]
  ds_read_b64_tr_b16 v[114:115], v146 offset:1024
  ds_read_b64_tr_b16 v[116:117], v147 offset:0
  ds_read_b64_tr_b16 v[118:119], v147 offset:1024
  v_mfma_f32_32x32x16_bf16 v[48:63], v[76:79], v[136:139], v[48:63]
  ds_read_b128 v[100:103], v155
  ds_read_b64_tr_b16 v[120:121], v144 offset:4096
  ds_read_b64_tr_b16 v[122:123], v144 offset:5120
  v_mfma_f32_32x32x16_bf16 v[0:15], v[80:83], v[140:143], v[0:15]
  s_waitcnt lgkmcnt(9)
  ds_read_b64_tr_b16 v[124:125], v145 offset:4096
  ds_read_b64_tr_b16 v[126:127], v145 offset:5120
  ds_read_b64_tr_b16 v[128:129], v146 offset:4096
  v_mfma_f32_32x32x16_bf16 v[16:31], v[84:87], v[140:143], v[16:31]
  s_waitcnt lgkmcnt(9)
  ds_read_b64_tr_b16 v[130:131], v146 offset:5120
  ds_read_b64_tr_b16 v[132:133], v147 offset:4096
  ds_read_b64_tr_b16 v[134:135], v147 offset:5120
  v_mfma_f32_32x32x16_bf16 v[32:47], v[88:91], v[140:143], v[32:47]
  v_mfma_f32_32x32x16_bf16 v[48:63], v[92:95], v[140:143], v[48:63]
  s_add_u32 s3, s3, 1
  s_and_b32 s3, s3, 15
  s_mov_b32 s59, s61
  s_add_u32 s61, s61, 32768
  s_cmp_eq_u32 s61, 163840
  s_cselect_b32 s61, 65536, s61
  s_cmp_ge_u32 s39, 2
  s_cbranch_scc0 concat_heads__gqa_block_cached__gqa_block_cached__near_ridge_kernel_nokv2
  s_cmp_lt_u32 s39, 6
  s_cbranch_scc0 concat_heads__gqa_block_cached__gqa_block_cached__near_ridge_kernel_nokv2
  s_add_u32 s35, s5, s32
  s_add_u32 s36, s4, s32
  s_add_u32 m0, s35, 16384
  s_add_u32 s38, s36, 0
  buffer_load_dwordx4 v157, s[20:23], s38 offen nt lds
  s_add_u32 m0, s35, 18432
  s_add_u32 s38, s36, 2048
  buffer_load_dwordx4 v157, s[20:23], s38 offen nt lds
  s_add_u32 m0, s35, 20480
  s_add_u32 s38, s36, 4096
  buffer_load_dwordx4 v157, s[20:23], s38 offen nt lds
  s_add_u32 m0, s35, 22528
  s_add_u32 s38, s36, 6144
  buffer_load_dwordx4 v157, s[20:23], s38 offen nt lds
  s_add_u32 s35, s39, 4294967295
  s_lshr_b32 s36, s35, 1
  s_and_b32 s35, s35, 1
  s_lshl_b32 s4, s36, 13
  s_add_u32 s4, s4, s58
  s_and_b32 s4, s4, 0x1ffff
  s_lshl_b32 s37, s35, 17
  s_add_u32 s4, s4, s37
  s_lshl_b32 s5, s36, 15
  s_lshl_b32 s37, s35, 13
  s_add_u32 s5, s5, s37
concat_heads__gqa_block_cached__gqa_block_cached__near_ridge_kernel_nokv2:
  s_waitcnt lgkmcnt(0)
  s_add_u32 s39, s39, 1
  s_cmp_lt_u32 s39, 6
  s_cbranch_scc1 concat_heads__gqa_block_cached__gqa_block_cached__near_ridge_kernel_ql0
  s_branch concat_heads__gqa_block_cached__gqa_block_cached__near_ridge_kernel_qtail
concat_heads__gqa_block_cached__gqa_block_cached__near_ridge_kernel_cls1:
  s_lshl_b32 s35, s3, 18
  s_add_u32 s35, s35, s31
  s_add_u32 s36, s40, 131072
  s_add_u32 m0, s36, 10240
  s_add_u32 s38, s35, 0
  buffer_load_dwordx4 v159, s[12:15], s38 offen lds
  s_add_u32 m0, s36, 11264
  s_add_u32 s38, s35, 32768
  buffer_load_dwordx4 v159, s[12:15], s38 offen lds
  s_add_u32 m0, s36, 12288
  s_add_u32 s38, s35, 65536
  buffer_load_dwordx4 v159, s[12:15], s38 offen lds
  s_add_u32 m0, s36, 13312
  s_add_u32 s38, s35, 98304
  buffer_load_dwordx4 v159, s[12:15], s38 offen lds
  s_lshl_b32 s35, s3, 6
  s_add_u32 s35, s35, s42
  s_add_u32 s36, s43, 131072
  s_add_u32 m0, s36, 0
  s_add_u32 s38, s35, 0
  buffer_load_dwordx4 v158, s[8:11], s38 offen lds
  s_add_u32 m0, s36, 1024
  s_add_u32 s38, s35, 16384
  buffer_load_dwordx4 v158, s[8:11], s38 offen lds
  s_add_u32 s3, s3, 1
  s_and_b32 s3, s3, 15
  s_lshl_b32 s35, s3, 18
  s_add_u32 s35, s35, s31
  s_add_u32 s36, s40, 65536
  s_add_u32 m0, s36, 10240
  s_add_u32 s38, s35, 0
  buffer_load_dwordx4 v159, s[12:15], s38 offen lds
  s_add_u32 m0, s36, 11264
  s_add_u32 s38, s35, 32768
  buffer_load_dwordx4 v159, s[12:15], s38 offen lds
  s_add_u32 m0, s36, 12288
  s_add_u32 s38, s35, 65536
  buffer_load_dwordx4 v159, s[12:15], s38 offen lds
  s_add_u32 m0, s36, 13312
  s_add_u32 s38, s35, 98304
  buffer_load_dwordx4 v159, s[12:15], s38 offen lds
  s_lshl_b32 s35, s3, 6
  s_add_u32 s35, s35, s42
  s_add_u32 s36, s43, 65536
  s_add_u32 m0, s36, 0
  s_add_u32 s38, s35, 0
  buffer_load_dwordx4 v158, s[8:11], s38 offen lds
  s_add_u32 m0, s36, 1024
  s_add_u32 s38, s35, 16384
  buffer_load_dwordx4 v158, s[8:11], s38 offen lds
  s_add_u32 s3, s3, 1
  s_and_b32 s3, s3, 15
  s_lshl_b32 s35, s3, 18
  s_add_u32 s35, s35, s31
  s_add_u32 s36, s40, 98304
  s_add_u32 m0, s36, 10240
  s_add_u32 s38, s35, 0
  buffer_load_dwordx4 v159, s[12:15], s38 offen lds
  s_add_u32 m0, s36, 11264
  s_add_u32 s38, s35, 32768
  buffer_load_dwordx4 v159, s[12:15], s38 offen lds
  s_add_u32 m0, s36, 12288
  s_add_u32 s38, s35, 65536
  buffer_load_dwordx4 v159, s[12:15], s38 offen lds
  s_add_u32 m0, s36, 13312
  s_add_u32 s38, s35, 98304
  buffer_load_dwordx4 v159, s[12:15], s38 offen lds
  s_lshl_b32 s35, s3, 6
  s_add_u32 s35, s35, s42
  s_add_u32 s36, s43, 98304
  s_add_u32 m0, s36, 0
  s_add_u32 s38, s35, 0
  buffer_load_dwordx4 v158, s[8:11], s38 offen lds
  s_add_u32 m0, s36, 1024
  s_add_u32 s38, s35, 16384
  buffer_load_dwordx4 v158, s[8:11], s38 offen lds
  s_add_u32 s3, s3, 1
  s_and_b32 s3, s3, 15
  v_lshrrev_b32 v1, 5, v162
  v_bfe_u32 v2, v162, 2, 2
  v_lshl_add_u32 v3, v1, 3, v2
  v_lshlrev_b32 v3, 8, v3
  v_lshl_add_u32 v3, v2, 6, v3
  v_bfe_u32 v4, v162, 4, 1
  v_lshl_add_u32 v3, v4, 5, v3
  v_and_b32 v4, 1, v162
  v_lshl_add_u32 v3, v4, 4, v3
  v_bfe_u32 v4, v162, 1, 1
  v_lshl_add_u32 v3, v4, 3, v3
  s_add_u32 s36, s40, 16384
  v_add_u32 v149, s36, v3
  v_and_b32 v2, 0x13, v162
  v_and_b32 v3, 4, v162
  v_lshl_or_b32 v2, v3, 1, v2
  v_and_b32 v3, 8, v162
  v_lshrrev_b32 v3, 1, v3
  v_or_b32 v2, v2, v3
  v_bfe_u32 v3, v2, 1, 3
  v_xor_b32 v3, v3, v1
  v_lshlrev_b32 v3, 4, v3
  v_lshl_add_u32 v3, v2, 7, v3
  v_add_u32 v148, s40, v3
  v_and_b32 v2, 31, v162
  v_bfe_u32 v3, v162, 2, 2
  v_xor_b32 v3, v3, v1
  v_lshlrev_b32 v3, 4, v3
  v_lshl_add_u32 v3, v2, 6, v3
  s_lshl_b32 s35, s30, 11
  v_add_u32 v160, s35, v3
  v_lshlrev_b32 v161, 4, v162
  v_mov_b32 v0, 0
  v_mov_b32 v1, 0
  v_mov_b32 v2, 0
  v_mov_b32 v3, 0
  v_mov_b32 v4, 0
  v_mov_b32 v5, 0
  v_mov_b32 v6, 0
  v_mov_b32 v7, 0
  v_mov_b32 v8, 0
  v_mov_b32 v9, 0
  v_mov_b32 v10, 0
  v_mov_b32 v11, 0
  v_mov_b32 v12, 0
  v_mov_b32 v13, 0
  v_mov_b32 v14, 0
  v_mov_b32 v15, 0
  v_mov_b32 v16, 0
  v_mov_b32 v17, 0
  v_mov_b32 v18, 0
  v_mov_b32 v19, 0
  v_mov_b32 v20, 0
  v_mov_b32 v21, 0
  v_mov_b32 v22, 0
  v_mov_b32 v23, 0
  v_mov_b32 v24, 0
  v_mov_b32 v25, 0
  v_mov_b32 v26, 0
  v_mov_b32 v27, 0
  v_mov_b32 v28, 0
  v_mov_b32 v29, 0
  v_mov_b32 v30, 0
  v_mov_b32 v31, 0
  v_mov_b32 v32, 0
  v_mov_b32 v33, 0
  v_mov_b32 v34, 0
  v_mov_b32 v35, 0
  v_mov_b32 v36, 0
  v_mov_b32 v37, 0
  v_mov_b32 v38, 0
  v_mov_b32 v39, 0
  v_mov_b32 v40, 0
  v_mov_b32 v41, 0
  v_mov_b32 v42, 0
  v_mov_b32 v43, 0
  v_mov_b32 v44, 0
  v_mov_b32 v45, 0
  v_mov_b32 v46, 0
  v_mov_b32 v47, 0
  v_mov_b32 v48, 0
  v_mov_b32 v49, 0
  v_mov_b32 v50, 0
  v_mov_b32 v51, 0
  v_mov_b32 v52, 0
  v_mov_b32 v53, 0
  v_mov_b32 v54, 0
  v_mov_b32 v55, 0
  v_mov_b32 v56, 0
  v_mov_b32 v57, 0
  v_mov_b32 v58, 0
  v_mov_b32 v59, 0
  v_mov_b32 v60, 0
  v_mov_b32 v61, 0
  v_mov_b32 v62, 0
  v_mov_b32 v63, 0
  s_waitcnt vmcnt(12)
  s_barrier
  v_add_u32 v144, 124928, v149
  v_add_u32 v154, 131072, v160
  v_xor_b32 v145, 64, v144
  v_xor_b32 v146, 128, v144
  v_xor_b32 v147, 192, v144
  v_xor_b32 v155, 32, v154
  ds_read_b128 v[96:99], v154
  ds_read_b64_tr_b16 v[104:105], v144 offset:0
  ds_read_b64_tr_b16 v[106:107], v144 offset:1024
  ds_read_b64_tr_b16 v[108:109], v145 offset:0
  ds_read_b64_tr_b16 v[110:111], v145 offset:1024
  ds_read_b64_tr_b16 v[112:113], v146 offset:0
  ds_read_b64_tr_b16 v[114:115], v146 offset:1024
  ds_read_b64_tr_b16 v[116:117], v147 offset:0
  ds_read_b64_tr_b16 v[118:119], v147 offset:1024
  ds_read_b128 v[100:103], v155
  ds_read_b64_tr_b16 v[120:121], v144 offset:4096
  ds_read_b64_tr_b16 v[122:123], v144 offset:5120
  ds_read_b64_tr_b16 v[124:125], v145 offset:4096
  ds_read_b64_tr_b16 v[126:127], v145 offset:5120
  s_waitcnt lgkmcnt(8)
  ds_read_b64_tr_b16 v[128:129], v146 offset:4096
  ds_read_b64_tr_b16 v[130:131], v146 offset:5120
  ds_read_b64_tr_b16 v[132:133], v147 offset:4096
  ds_read_b64_tr_b16 v[134:135], v147 offset:5120
  s_waitcnt lgkmcnt(0)
  s_mov_b32 s59, 131072
  s_mov_b32 s61, 65536
  s_mov_b32 s39, 0
  s_mov_b32 s4, s58
  s_mov_b32 s5, 0
concat_heads__gqa_block_cached__gqa_block_cached__near_ridge_kernel_ql1:
  s_waitcnt vmcnt(6)
  s_barrier
  s_add_u32 s37, s61, 4294961152
  v_add_u32 v144, s37, v149
  v_add_u32 v154, s61, v160
  v_xor_b32 v145, 64, v144
  v_xor_b32 v146, 128, v144
  v_xor_b32 v147, 192, v144
  v_xor_b32 v155, 32, v154
  s_lshl_b32 s35, s3, 18
  s_add_u32 s35, s35, s31
  s_add_u32 s36, s59, s40
  s_add_u32 m0, s36, 10240
  s_add_u32 s38, s35, 0
  buffer_load_dwordx4 v159, s[12:15], s38 offen lds
  s_add_u32 m0, s36, 11264
  s_add_u32 s38, s35, 32768
  buffer_load_dwordx4 v159, s[12:15], s38 offen lds
  s_add_u32 m0, s36, 12288
  s_add_u32 s38, s35, 65536
  buffer_load_dwordx4 v159, s[12:15], s38 offen lds
  s_add_u32 m0, s36, 13312
  s_add_u32 s38, s35, 98304
  buffer_load_dwordx4 v159, s[12:15], s38 offen lds
  s_lshl_b32 s35, s3, 6
  s_add_u32 s35, s35, s42
  s_add_u32 s36, s59, s43
  s_add_u32 m0, s36, 0
  s_add_u32 s38, s35, 0
  buffer_load_dwordx4 v158, s[8:11], s38 offen lds
  s_add_u32 m0, s36, 1024
  s_add_u32 s38, s35, 16384
  buffer_load_dwordx4 v158, s[8:11], s38 offen lds
  v_mfma_f32_32x32x16_bf16 v[0:15], v[104:107], v[96:99], v[0:15]
  ds_read_b128 v[136:139], v154
  ds_read_b64_tr_b16 v[64:65], v144 offset:0
  ds_read_b64_tr_b16 v[66:67], v144 offset:1024
  v_mfma_f32_32x32x16_bf16 v[16:31], v[108:111], v[96:99], v[16:31]
  ds_read_b64_tr_b16 v[68:69], v145 offset:0
  ds_read_b64_tr_b16 v[70:71], v145 offset:1024
  ds_read_b64_tr_b16 v[72:73], v146 offset:0
  v_mfma_f32_32x32x16_bf16 v[32:47], v[112:115], v[96:99], v[32:47]
  ds_read_b64_tr_b16 v[74:75], v146 offset:1024
  ds_read_b64_tr_b16 v[76:77], v147 offset:0
  ds_read_b64_tr_b16 v[78:79], v147 offset:1024
  v_mfma_f32_32x32x16_bf16 v[48:63], v[116:119], v[96:99], v[48:63]
  ds_read_b128 v[140:143], v155
  ds_read_b64_tr_b16 v[80:81], v144 offset:4096
  ds_read_b64_tr_b16 v[82:83], v144 offset:5120
  v_mfma_f32_32x32x16_bf16 v[0:15], v[120:123], v[100:103], v[0:15]
  s_waitcnt lgkmcnt(9)
  ds_read_b64_tr_b16 v[84:85], v145 offset:4096
  ds_read_b64_tr_b16 v[86:87], v145 offset:5120
  ds_read_b64_tr_b16 v[88:89], v146 offset:4096
  v_mfma_f32_32x32x16_bf16 v[16:31], v[124:127], v[100:103], v[16:31]
  s_waitcnt lgkmcnt(9)
  ds_read_b64_tr_b16 v[90:91], v146 offset:5120
  ds_read_b64_tr_b16 v[92:93], v147 offset:4096
  ds_read_b64_tr_b16 v[94:95], v147 offset:5120
  v_mfma_f32_32x32x16_bf16 v[32:47], v[128:131], v[100:103], v[32:47]
  v_mfma_f32_32x32x16_bf16 v[48:63], v[132:135], v[100:103], v[48:63]
  s_add_u32 s3, s3, 1
  s_and_b32 s3, s3, 15
  s_mov_b32 s59, s61
  s_add_u32 s61, s61, 32768
  s_cmp_eq_u32 s61, 163840
  s_cselect_b32 s61, 65536, s61
  s_waitcnt lgkmcnt(0)
  s_waitcnt vmcnt(6)
  s_barrier
  s_add_u32 s37, s61, 4294961152
  v_add_u32 v144, s37, v149
  v_add_u32 v154, s61, v160
  v_xor_b32 v145, 64, v144
  v_xor_b32 v146, 128, v144
  v_xor_b32 v147, 192, v144
  v_xor_b32 v155, 32, v154
  s_lshl_b32 s35, s3, 18
  s_add_u32 s35, s35, s31
  s_add_u32 s36, s59, s40
  s_add_u32 m0, s36, 10240
  s_add_u32 s38, s35, 0
  buffer_load_dwordx4 v159, s[12:15], s38 offen lds
  s_add_u32 m0, s36, 11264
  s_add_u32 s38, s35, 32768
  buffer_load_dwordx4 v159, s[12:15], s38 offen lds
  s_add_u32 m0, s36, 12288
  s_add_u32 s38, s35, 65536
  buffer_load_dwordx4 v159, s[12:15], s38 offen lds
  s_add_u32 m0, s36, 13312
  s_add_u32 s38, s35, 98304
  buffer_load_dwordx4 v159, s[12:15], s38 offen lds
  s_lshl_b32 s35, s3, 6
  s_add_u32 s35, s35, s42
  s_add_u32 s36, s59, s43
  s_add_u32 m0, s36, 0
  s_add_u32 s38, s35, 0
  buffer_load_dwordx4 v158, s[8:11], s38 offen lds
  s_add_u32 m0, s36, 1024
  s_add_u32 s38, s35, 16384
  buffer_load_dwordx4 v158, s[8:11], s38 offen lds
  v_mfma_f32_32x32x16_bf16 v[0:15], v[64:67], v[136:139], v[0:15]
  ds_read_b128 v[96:99], v154
  ds_read_b64_tr_b16 v[104:105], v144 offset:0
  ds_read_b64_tr_b16 v[106:107], v144 offset:1024
  v_mfma_f32_32x32x16_bf16 v[16:31], v[68:71], v[136:139], v[16:31]
  ds_read_b64_tr_b16 v[108:109], v145 offset:0
  ds_read_b64_tr_b16 v[110:111], v145 offset:1024
  ds_read_b64_tr_b16 v[112:113], v146 offset:0
  v_mfma_f32_32x32x16_bf16 v[32:47], v[72:75], v[136:139], v[32:47]
  ds_read_b64_tr_b16 v[114:115], v146 offset:1024
  ds_read_b64_tr_b16 v[116:117], v147 offset:0
  ds_read_b64_tr_b16 v[118:119], v147 offset:1024
  v_mfma_f32_32x32x16_bf16 v[48:63], v[76:79], v[136:139], v[48:63]
  ds_read_b128 v[100:103], v155
  ds_read_b64_tr_b16 v[120:121], v144 offset:4096
  ds_read_b64_tr_b16 v[122:123], v144 offset:5120
  v_mfma_f32_32x32x16_bf16 v[0:15], v[80:83], v[140:143], v[0:15]
  s_waitcnt lgkmcnt(9)
  ds_read_b64_tr_b16 v[124:125], v145 offset:4096
  ds_read_b64_tr_b16 v[126:127], v145 offset:5120
  ds_read_b64_tr_b16 v[128:129], v146 offset:4096
  v_mfma_f32_32x32x16_bf16 v[16:31], v[84:87], v[140:143], v[16:31]
  s_waitcnt lgkmcnt(9)
  ds_read_b64_tr_b16 v[130:131], v146 offset:5120
  ds_read_b64_tr_b16 v[132:133], v147 offset:4096
  ds_read_b64_tr_b16 v[134:135], v147 offset:5120
  v_mfma_f32_32x32x16_bf16 v[32:47], v[88:91], v[140:143], v[32:47]
  v_mfma_f32_32x32x16_bf16 v[48:63], v[92:95], v[140:143], v[48:63]
  s_add_u32 s3, s3, 1
  s_and_b32 s3, s3, 15
  s_mov_b32 s59, s61
  s_add_u32 s61, s61, 32768
  s_cmp_eq_u32 s61, 163840
  s_cselect_b32 s61, 65536, s61
  s_waitcnt lgkmcnt(0)
  s_add_u32 s39, s39, 1
  s_cmp_lt_u32 s39, 6
  s_cbranch_scc1 concat_heads__gqa_block_cached__gqa_block_cached__near_ridge_kernel_ql1
  s_branch concat_heads__gqa_block_cached__gqa_block_cached__near_ridge_kernel_qtail
concat_heads__gqa_block_cached__gqa_block_cached__near_ridge_kernel_cls2:
  s_add_u32 s3, s3, 1
  s_and_b32 s3, s3, 15
  s_add_u32 s3, s3, 1
  s_and_b32 s3, s3, 15
  s_add_u32 s3, s3, 1
  s_and_b32 s3, s3, 15
  v_lshrrev_b32 v1, 5, v162
  v_bfe_u32 v2, v162, 2, 2
  v_lshl_add_u32 v3, v1, 3, v2
  v_lshlrev_b32 v3, 8, v3
  v_lshl_add_u32 v3, v2, 6, v3
  v_bfe_u32 v4, v162, 4, 1
  v_lshl_add_u32 v3, v4, 5, v3
  v_and_b32 v4, 1, v162
  v_lshl_add_u32 v3, v4, 4, v3
  v_bfe_u32 v4, v162, 1, 1
  v_lshl_add_u32 v3, v4, 3, v3
  s_add_u32 s36, s40, 16384
  v_add_u32 v149, s36, v3
  v_and_b32 v2, 0x13, v162
  v_and_b32 v3, 4, v162
  v_lshl_or_b32 v2, v3, 1, v2
  v_and_b32 v3, 8, v162
  v_lshrrev_b32 v3, 1, v3
  v_or_b32 v2, v2, v3
  v_bfe_u32 v3, v2, 1, 3
  v_xor_b32 v3, v3, v1
  v_lshlrev_b32 v3, 4, v3
  v_lshl_add_u32 v3, v2, 7, v3
  v_add_u32 v148, s40, v3
  v_and_b32 v2, 31, v162
  v_bfe_u32 v3, v162, 2, 2
  v_xor_b32 v3, v3, v1
  v_lshlrev_b32 v3, 4, v3
  v_lshl_add_u32 v3, v2, 6, v3
  s_lshl_b32 s35, s30, 11
  v_add_u32 v160, s35, v3
  v_lshlrev_b32 v161, 4, v162
  v_mov_b32 v0, 0
  v_mov_b32 v1, 0
  v_mov_b32 v2, 0
  v_mov_b32 v3, 0
  v_mov_b32 v4, 0
  v_mov_b32 v5, 0
  v_mov_b32 v6, 0
  v_mov_b32 v7, 0
  v_mov_b32 v8, 0
  v_mov_b32 v9, 0
  v_mov_b32 v10, 0
  v_mov_b32 v11, 0
  v_mov_b32 v12, 0
  v_mov_b32 v13, 0
  v_mov_b32 v14, 0
  v_mov_b32 v15, 0
  v_mov_b32 v16, 0
  v_mov_b32 v17, 0
  v_mov_b32 v18, 0
  v_mov_b32 v19, 0
  v_mov_b32 v20, 0
  v_mov_b32 v21, 0
  v_mov_b32 v22, 0
  v_mov_b32 v23, 0
  v_mov_b32 v24, 0
  v_mov_b32 v25, 0
  v_mov_b32 v26, 0
  v_mov_b32 v27, 0
  v_mov_b32 v28, 0
  v_mov_b32 v29, 0
  v_mov_b32 v30, 0
  v_mov_b32 v31, 0
  v_mov_b32 v32, 0
  v_mov_b32 v33, 0
  v_mov_b32 v34, 0
  v_mov_b32 v35, 0
  v_mov_b32 v36, 0
  v_mov_b32 v37, 0
  v_mov_b32 v38, 0
  v_mov_b32 v39, 0
  v_mov_b32 v40, 0
  v_mov_b32 v41, 0
  v_mov_b32 v42, 0
  v_mov_b32 v43, 0
  v_mov_b32 v44, 0
  v_mov_b32 v45, 0
  v_mov_b32 v46, 0
  v_mov_b32 v47, 0
  v_mov_b32 v48, 0
  v_mov_b32 v49, 0
  v_mov_b32 v50, 0
  v_mov_b32 v51, 0
  v_mov_b32 v52, 0
  v_mov_b32 v53, 0
  v_mov_b32 v54, 0
  v_mov_b32 v55, 0
  v_mov_b32 v56, 0
  v_mov_b32 v57, 0
  v_mov_b32 v58, 0
  v_mov_b32 v59, 0
  v_mov_b32 v60, 0
  v_mov_b32 v61, 0
  v_mov_b32 v62, 0
  v_mov_b32 v63, 0
  s_barrier
  v_add_u32 v144, 124928, v149
  v_add_u32 v154, 131072, v160
  v_xor_b32 v145, 64, v144
  v_xor_b32 v146, 128, v144
  v_xor_b32 v147, 192, v144
  v_xor_b32 v155, 32, v154
  ds_read_b128 v[96:99], v154
  ds_read_b64_tr_b16 v[104:105], v144 offset:0
  ds_read_b64_tr_b16 v[106:107], v144 offset:1024
  ds_read_b64_tr_b16 v[108:109], v145 offset:0
  ds_read_b64_tr_b16 v[110:111], v145 offset:1024
  ds_read_b64_tr_b16 v[112:113], v146 offset:0
  ds_read_b64_tr_b16 v[114:115], v146 offset:1024
  ds_read_b64_tr_b16 v[116:117], v147 offset:0
  ds_read_b64_tr_b16 v[118:119], v147 offset:1024
  ds_read_b128 v[100:103], v155
  ds_read_b64_tr_b16 v[120:121], v144 offset:4096
  ds_read_b64_tr_b16 v[122:123], v144 offset:5120
  ds_read_b64_tr_b16 v[124:125], v145 offset:4096
  ds_read_b64_tr_b16 v[126:127], v145 offset:5120
  s_waitcnt lgkmcnt(8)
  ds_read_b64_tr_b16 v[128:129], v146 offset:4096
  ds_read_b64_tr_b16 v[130:131], v146 offset:5120
  ds_read_b64_tr_b16 v[132:133], v147 offset:4096
  ds_read_b64_tr_b16 v[134:135], v147 offset:5120
  s_waitcnt lgkmcnt(0)
  s_mov_b32 s59, 131072
  s_mov_b32 s61, 65536
  s_mov_b32 s39, 0
  s_mov_b32 s4, s58
  s_mov_b32 s5, 0
concat_heads__gqa_block_cached__gqa_block_cached__near_ridge_kernel_ql2:
  s_barrier
  s_add_u32 s37, s61, 4294961152
  v_add_u32 v144, s37, v149
  v_add_u32 v154, s61, v160
  v_xor_b32 v145, 64, v144
  v_xor_b32 v146, 128, v144
  v_xor_b32 v147, 192, v144
  v_xor_b32 v155, 32, v154
  v_mfma_f32_32x32x16_bf16 v[0:15], v[104:107], v[96:99], v[0:15]
  ds_read_b128 v[136:139], v154
  ds_read_b64_tr_b16 v[64:65], v144 offset:0
  ds_read_b64_tr_b16 v[66:67], v144 offset:1024
  v_mfma_f32_32x32x16_bf16 v[16:31], v[108:111], v[96:99], v[16:31]
  ds_read_b64_tr_b16 v[68:69], v145 offset:0
  ds_read_b64_tr_b16 v[70:71], v145 offset:1024
  ds_read_b64_tr_b16 v[72:73], v146 offset:0
  v_mfma_f32_32x32x16_bf16 v[32:47], v[112:115], v[96:99], v[32:47]
  ds_read_b64_tr_b16 v[74:75], v146 offset:1024
  ds_read_b64_tr_b16 v[76:77], v147 offset:0
  ds_read_b64_tr_b16 v[78:79], v147 offset:1024
  v_mfma_f32_32x32x16_bf16 v[48:63], v[116:119], v[96:99], v[48:63]
  ds_read_b128 v[140:143], v155
  ds_read_b64_tr_b16 v[80:81], v144 offset:4096
  ds_read_b64_tr_b16 v[82:83], v144 offset:5120
  v_mfma_f32_32x32x16_bf16 v[0:15], v[120:123], v[100:103], v[0:15]
  s_waitcnt lgkmcnt(9)
  ds_read_b64_tr_b16 v[84:85], v145 offset:4096
  ds_read_b64_tr_b16 v[86:87], v145 offset:5120
  ds_read_b64_tr_b16 v[88:89], v146 offset:4096
  v_mfma_f32_32x32x16_bf16 v[16:31], v[124:127], v[100:103], v[16:31]
  s_waitcnt lgkmcnt(9)
  ds_read_b64_tr_b16 v[90:91], v146 offset:5120
  ds_read_b64_tr_b16 v[92:93], v147 offset:4096
  ds_read_b64_tr_b16 v[94:95], v147 offset:5120
  v_mfma_f32_32x32x16_bf16 v[32:47], v[128:131], v[100:103], v[32:47]
  v_mfma_f32_32x32x16_bf16 v[48:63], v[132:135], v[100:103], v[48:63]
  s_add_u32 s3, s3, 1
  s_and_b32 s3, s3, 15
  s_mov_b32 s59, s61
  s_add_u32 s61, s61, 32768
  s_cmp_eq_u32 s61, 163840
  s_cselect_b32 s61, 65536, s61
  s_waitcnt lgkmcnt(0)
  s_barrier
  s_add_u32 s37, s61, 4294961152
  v_add_u32 v144, s37, v149
  v_add_u32 v154, s61, v160
  v_xor_b32 v145, 64, v144
  v_xor_b32 v146, 128, v144
  v_xor_b32 v147, 192, v144
  v_xor_b32 v155, 32, v154
  v_mfma_f32_32x32x16_bf16 v[0:15], v[64:67], v[136:139], v[0:15]
  ds_read_b128 v[96:99], v154
  ds_read_b64_tr_b16 v[104:105], v144 offset:0
  ds_read_b64_tr_b16 v[106:107], v144 offset:1024
  v_mfma_f32_32x32x16_bf16 v[16:31], v[68:71], v[136:139], v[16:31]
  ds_read_b64_tr_b16 v[108:109], v145 offset:0
  ds_read_b64_tr_b16 v[110:111], v145 offset:1024
  ds_read_b64_tr_b16 v[112:113], v146 offset:0
  v_mfma_f32_32x32x16_bf16 v[32:47], v[72:75], v[136:139], v[32:47]
  ds_read_b64_tr_b16 v[114:115], v146 offset:1024
  ds_read_b64_tr_b16 v[116:117], v147 offset:0
  ds_read_b64_tr_b16 v[118:119], v147 offset:1024
  v_mfma_f32_32x32x16_bf16 v[48:63], v[76:79], v[136:139], v[48:63]
  ds_read_b128 v[100:103], v155
  ds_read_b64_tr_b16 v[120:121], v144 offset:4096
  ds_read_b64_tr_b16 v[122:123], v144 offset:5120
  v_mfma_f32_32x32x16_bf16 v[0:15], v[80:83], v[140:143], v[0:15]
  s_waitcnt lgkmcnt(9)
  ds_read_b64_tr_b16 v[124:125], v145 offset:4096
  ds_read_b64_tr_b16 v[126:127], v145 offset:5120
  ds_read_b64_tr_b16 v[128:129], v146 offset:4096
  v_mfma_f32_32x32x16_bf16 v[16:31], v[84:87], v[140:143], v[16:31]
  s_waitcnt lgkmcnt(9)
  ds_read_b64_tr_b16 v[130:131], v146 offset:5120
  ds_read_b64_tr_b16 v[132:133], v147 offset:4096
  ds_read_b64_tr_b16 v[134:135], v147 offset:5120
  v_mfma_f32_32x32x16_bf16 v[32:47], v[88:91], v[140:143], v[32:47]
  v_mfma_f32_32x32x16_bf16 v[48:63], v[92:95], v[140:143], v[48:63]
  s_add_u32 s3, s3, 1
  s_and_b32 s3, s3, 15
  s_mov_b32 s59, s61
  s_add_u32 s61, s61, 32768
  s_cmp_eq_u32 s61, 163840
  s_cselect_b32 s61, 65536, s61
  s_waitcnt lgkmcnt(0)
  s_add_u32 s39, s39, 1
  s_cmp_lt_u32 s39, 6
  s_cbranch_scc1 concat_heads__gqa_block_cached__gqa_block_cached__near_ridge_kernel_ql2
  s_branch concat_heads__gqa_block_cached__gqa_block_cached__near_ridge_kernel_qtail
concat_heads__gqa_block_cached__gqa_block_cached__near_ridge_kernel_cls3:
  s_lshl_b32 s35, s3, 18
  s_add_u32 s35, s35, s31
  s_add_u32 s36, s40, 131072
  s_add_u32 m0, s36, 14336
  s_add_u32 s38, s35, 131072
  buffer_load_dwordx4 v159, s[12:15], s38 offen lds
  s_add_u32 m0, s36, 15360
  s_add_u32 s38, s35, 163840
  buffer_load_dwordx4 v159, s[12:15], s38 offen lds
  s_add_u32 m0, s36, 16384
  s_add_u32 s38, s35, 196608
  buffer_load_dwordx4 v159, s[12:15], s38 offen lds
  s_add_u32 m0, s36, 17408
  s_add_u32 s38, s35, 229376
  buffer_load_dwordx4 v159, s[12:15], s38 offen lds
  s_lshl_b32 s35, s3, 6
  s_add_u32 s35, s35, s42
  s_add_u32 s36, s43, 131072
  s_add_u32 m0, s36, 2048
  s_add_u32 s38, s35, 32768
  buffer_load_dwordx4 v158, s[8:11], s38 offen lds
  s_add_u32 m0, s36, 3072
  s_add_u32 s38, s35, 49152
  buffer_load_dwordx4 v158, s[8:11], s38 offen lds
  s_add_u32 m0, s36, 4096
  s_add_u32 s38, s35, 65536
  buffer_load_dwordx4 v158, s[8:11], s38 offen lds
  s_add_u32 s3, s3, 1
  s_and_b32 s3, s3, 15
  s_lshl_b32 s35, s3, 18
  s_add_u32 s35, s35, s31
  s_add_u32 s36, s40, 65536
  s_add_u32 m0, s36, 14336
  s_add_u32 s38, s35, 131072
  buffer_load_dwordx4 v159, s[12:15], s38 offen lds
  s_add_u32 m0, s36, 15360
  s_add_u32 s38, s35, 163840
  buffer_load_dwordx4 v159, s[12:15], s38 offen lds
  s_add_u32 m0, s36, 16384
  s_add_u32 s38, s35, 196608
  buffer_load_dwordx4 v159, s[12:15], s38 offen lds
  s_add_u32 m0, s36, 17408
  s_add_u32 s38, s35, 229376
  buffer_load_dwordx4 v159, s[12:15], s38 offen lds
  s_lshl_b32 s35, s3, 6
  s_add_u32 s35, s35, s42
  s_add_u32 s36, s43, 65536
  s_add_u32 m0, s36, 2048
  s_add_u32 s38, s35, 32768
  buffer_load_dwordx4 v158, s[8:11], s38 offen lds
  s_add_u32 m0, s36, 3072
  s_add_u32 s38, s35, 49152
  buffer_load_dwordx4 v158, s[8:11], s38 offen lds
  s_add_u32 m0, s36, 4096
  s_add_u32 s38, s35, 65536
  buffer_load_dwordx4 v158, s[8:11], s38 offen lds
  s_add_u32 s3, s3, 1
  s_and_b32 s3, s3, 15
  s_lshl_b32 s35, s3, 18
  s_add_u32 s35, s35, s31
  s_add_u32 s36, s40, 98304
  s_add_u32 m0, s36, 14336
  s_add_u32 s38, s35, 131072
  buffer_load_dwordx4 v159, s[12:15], s38 offen lds
  s_add_u32 m0, s36, 15360
  s_add_u32 s38, s35, 163840
  buffer_load_dwordx4 v159, s[12:15], s38 offen lds
  s_add_u32 m0, s36, 16384
  s_add_u32 s38, s35, 196608
  buffer_load_dwordx4 v159, s[12:15], s38 offen lds
  s_add_u32 m0, s36, 17408
  s_add_u32 s38, s35, 229376
  buffer_load_dwordx4 v159, s[12:15], s38 offen lds
  s_lshl_b32 s35, s3, 6
  s_add_u32 s35, s35, s42
  s_add_u32 s36, s43, 98304
  s_add_u32 m0, s36, 2048
  s_add_u32 s38, s35, 32768
  buffer_load_dwordx4 v158, s[8:11], s38 offen lds
  s_add_u32 m0, s36, 3072
  s_add_u32 s38, s35, 49152
  buffer_load_dwordx4 v158, s[8:11], s38 offen lds
  s_add_u32 m0, s36, 4096
  s_add_u32 s38, s35, 65536
  buffer_load_dwordx4 v158, s[8:11], s38 offen lds
  s_add_u32 s3, s3, 1
  s_and_b32 s3, s3, 15
  v_lshrrev_b32 v1, 5, v162
  v_bfe_u32 v2, v162, 2, 2
  v_lshl_add_u32 v3, v1, 3, v2
  v_lshlrev_b32 v3, 8, v3
  v_lshl_add_u32 v3, v2, 6, v3
  v_bfe_u32 v4, v162, 4, 1
  v_lshl_add_u32 v3, v4, 5, v3
  v_and_b32 v4, 1, v162
  v_lshl_add_u32 v3, v4, 4, v3
  v_bfe_u32 v4, v162, 1, 1
  v_lshl_add_u32 v3, v4, 3, v3
  s_add_u32 s36, s40, 16384
  v_add_u32 v149, s36, v3
  v_and_b32 v2, 0x13, v162
  v_and_b32 v3, 4, v162
  v_lshl_or_b32 v2, v3, 1, v2
  v_and_b32 v3, 8, v162
  v_lshrrev_b32 v3, 1, v3
  v_or_b32 v2, v2, v3
  v_bfe_u32 v3, v2, 1, 3
  v_xor_b32 v3, v3, v1
  v_lshlrev_b32 v3, 4, v3
  v_lshl_add_u32 v3, v2, 7, v3
  v_add_u32 v148, s40, v3
  v_and_b32 v2, 31, v162
  v_bfe_u32 v3, v162, 2, 2
  v_xor_b32 v3, v3, v1
  v_lshlrev_b32 v3, 4, v3
  v_lshl_add_u32 v3, v2, 6, v3
  s_lshl_b32 s35, s30, 11
  v_add_u32 v160, s35, v3
  v_lshlrev_b32 v161, 4, v162
  v_mov_b32 v0, 0
  v_mov_b32 v1, 0
  v_mov_b32 v2, 0
  v_mov_b32 v3, 0
  v_mov_b32 v4, 0
  v_mov_b32 v5, 0
  v_mov_b32 v6, 0
  v_mov_b32 v7, 0
  v_mov_b32 v8, 0
  v_mov_b32 v9, 0
  v_mov_b32 v10, 0
  v_mov_b32 v11, 0
  v_mov_b32 v12, 0
  v_mov_b32 v13, 0
  v_mov_b32 v14, 0
  v_mov_b32 v15, 0
  v_mov_b32 v16, 0
  v_mov_b32 v17, 0
  v_mov_b32 v18, 0
  v_mov_b32 v19, 0
  v_mov_b32 v20, 0
  v_mov_b32 v21, 0
  v_mov_b32 v22, 0
  v_mov_b32 v23, 0
  v_mov_b32 v24, 0
  v_mov_b32 v25, 0
  v_mov_b32 v26, 0
  v_mov_b32 v27, 0
  v_mov_b32 v28, 0
  v_mov_b32 v29, 0
  v_mov_b32 v30, 0
  v_mov_b32 v31, 0
  v_mov_b32 v32, 0
  v_mov_b32 v33, 0
  v_mov_b32 v34, 0
  v_mov_b32 v35, 0
  v_mov_b32 v36, 0
  v_mov_b32 v37, 0
  v_mov_b32 v38, 0
  v_mov_b32 v39, 0
  v_mov_b32 v40, 0
  v_mov_b32 v41, 0
  v_mov_b32 v42, 0
  v_mov_b32 v43, 0
  v_mov_b32 v44, 0
  v_mov_b32 v45, 0
  v_mov_b32 v46, 0
  v_mov_b32 v47, 0
  v_mov_b32 v48, 0
  v_mov_b32 v49, 0
  v_mov_b32 v50, 0
  v_mov_b32 v51, 0
  v_mov_b32 v52, 0
  v_mov_b32 v53, 0
  v_mov_b32 v54, 0
  v_mov_b32 v55, 0
  v_mov_b32 v56, 0
  v_mov_b32 v57, 0
  v_mov_b32 v58, 0
  v_mov_b32 v59, 0
  v_mov_b32 v60, 0
  v_mov_b32 v61, 0
  v_mov_b32 v62, 0
  v_mov_b32 v63, 0
  s_waitcnt vmcnt(14)
  s_barrier
  v_add_u32 v144, 124928, v149
  v_add_u32 v154, 131072, v160
  v_xor_b32 v145, 64, v144
  v_xor_b32 v146, 128, v144
  v_xor_b32 v147, 192, v144
  v_xor_b32 v155, 32, v154
  ds_read_b128 v[96:99], v154
  ds_read_b64_tr_b16 v[104:105], v144 offset:0
  ds_read_b64_tr_b16 v[106:107], v144 offset:1024
  ds_read_b64_tr_b16 v[108:109], v145 offset:0
  ds_read_b64_tr_b16 v[110:111], v145 offset:1024
  ds_read_b64_tr_b16 v[112:113], v146 offset:0
  ds_read_b64_tr_b16 v[114:115], v146 offset:1024
  ds_read_b64_tr_b16 v[116:117], v147 offset:0
  ds_read_b64_tr_b16 v[118:119], v147 offset:1024
  ds_read_b128 v[100:103], v155
  ds_read_b64_tr_b16 v[120:121], v144 offset:4096
  ds_read_b64_tr_b16 v[122:123], v144 offset:5120
  ds_read_b64_tr_b16 v[124:125], v145 offset:4096
  ds_read_b64_tr_b16 v[126:127], v145 offset:5120
  s_waitcnt lgkmcnt(8)
  ds_read_b64_tr_b16 v[128:129], v146 offset:4096
  ds_read_b64_tr_b16 v[130:131], v146 offset:5120
  ds_read_b64_tr_b16 v[132:133], v147 offset:4096
  ds_read_b64_tr_b16 v[134:135], v147 offset:5120
  s_waitcnt lgkmcnt(0)
  s_mov_b32 s59, 131072
  s_mov_b32 s61, 65536
  s_mov_b32 s39, 0
  s_mov_b32 s4, s58
  s_mov_b32 s5, 0
concat_heads__gqa_block_cached__gqa_block_cached__near_ridge_kernel_ql3:
  s_waitcnt vmcnt(7)
  s_barrier
  s_add_u32 s37, s61, 4294961152
  v_add_u32 v144, s37, v149
  v_add_u32 v154, s61, v160
  v_xor_b32 v145, 64, v144
  v_xor_b32 v146, 128, v144
  v_xor_b32 v147, 192, v144
  v_xor_b32 v155, 32, v154
  s_lshl_b32 s35, s3, 18
  s_add_u32 s35, s35, s31
  s_add_u32 s36, s59, s40
  s_add_u32 m0, s36, 14336
  s_add_u32 s38, s35, 131072
  buffer_load_dwordx4 v159, s[12:15], s38 offen lds
  s_add_u32 m0, s36, 15360
  s_add_u32 s38, s35, 163840
  buffer_load_dwordx4 v159, s[12:15], s38 offen lds
  s_add_u32 m0, s36, 16384
  s_add_u32 s38, s35, 196608
  buffer_load_dwordx4 v159, s[12:15], s38 offen lds
  s_add_u32 m0, s36, 17408
  s_add_u32 s38, s35, 229376
  buffer_load_dwordx4 v159, s[12:15], s38 offen lds
  s_lshl_b32 s35, s3, 6
  s_add_u32 s35, s35, s42
  s_add_u32 s36, s59, s43
  s_add_u32 m0, s36, 2048
  s_add_u32 s38, s35, 32768
  buffer_load_dwordx4 v158, s[8:11], s38 offen lds
  s_add_u32 m0, s36, 3072
  s_add_u32 s38, s35, 49152
  buffer_load_dwordx4 v158, s[8:11], s38 offen lds
  s_add_u32 m0, s36, 4096
  s_add_u32 s38, s35, 65536
  buffer_load_dwordx4 v158, s[8:11], s38 offen lds
  v_mfma_f32_32x32x16_bf16 v[0:15], v[104:107], v[96:99], v[0:15]
  ds_read_b128 v[136:139], v154
  ds_read_b64_tr_b16 v[64:65], v144 offset:0
  ds_read_b64_tr_b16 v[66:67], v144 offset:1024
  v_mfma_f32_32x32x16_bf16 v[16:31], v[108:111], v[96:99], v[16:31]
  ds_read_b64_tr_b16 v[68:69], v145 offset:0
  ds_read_b64_tr_b16 v[70:71], v145 offset:1024
  ds_read_b64_tr_b16 v[72:73], v146 offset:0
  v_mfma_f32_32x32x16_bf16 v[32:47], v[112:115], v[96:99], v[32:47]
  ds_read_b64_tr_b16 v[74:75], v146 offset:1024
  ds_read_b64_tr_b16 v[76:77], v147 offset:0
  ds_read_b64_tr_b16 v[78:79], v147 offset:1024
  v_mfma_f32_32x32x16_bf16 v[48:63], v[116:119], v[96:99], v[48:63]
  ds_read_b128 v[140:143], v155
  ds_read_b64_tr_b16 v[80:81], v144 offset:4096
  ds_read_b64_tr_b16 v[82:83], v144 offset:5120
  v_mfma_f32_32x32x16_bf16 v[0:15], v[120:123], v[100:103], v[0:15]
  s_waitcnt lgkmcnt(9)
  ds_read_b64_tr_b16 v[84:85], v145 offset:4096
  ds_read_b64_tr_b16 v[86:87], v145 offset:5120
  ds_read_b64_tr_b16 v[88:89], v146 offset:4096
  v_mfma_f32_32x32x16_bf16 v[16:31], v[124:127], v[100:103], v[16:31]
  s_waitcnt lgkmcnt(9)
  ds_read_b64_tr_b16 v[90:91], v146 offset:5120
  ds_read_b64_tr_b16 v[92:93], v147 offset:4096
  ds_read_b64_tr_b16 v[94:95], v147 offset:5120
  v_mfma_f32_32x32x16_bf16 v[32:47], v[128:131], v[100:103], v[32:47]
  v_mfma_f32_32x32x16_bf16 v[48:63], v[132:135], v[100:103], v[48:63]
  s_add_u32 s3, s3, 1
  s_and_b32 s3, s3, 15
  s_mov_b32 s59, s61
  s_add_u32 s61, s61, 32768
  s_cmp_eq_u32 s61, 163840
  s_cselect_b32 s61, 65536, s61
  s_waitcnt lgkmcnt(0)
  s_waitcnt vmcnt(7)
  s_barrier
  s_add_u32 s37, s61, 4294961152
  v_add_u32 v144, s37, v149
  v_add_u32 v154, s61, v160
  v_xor_b32 v145, 64, v144
  v_xor_b32 v146, 128, v144
  v_xor_b32 v147, 192, v144
  v_xor_b32 v155, 32, v154
  s_lshl_b32 s35, s3, 18
  s_add_u32 s35, s35, s31
  s_add_u32 s36, s59, s40
  s_add_u32 m0, s36, 14336
  s_add_u32 s38, s35, 131072
  buffer_load_dwordx4 v159, s[12:15], s38 offen lds
  s_add_u32 m0, s36, 15360
  s_add_u32 s38, s35, 163840
  buffer_load_dwordx4 v159, s[12:15], s38 offen lds
  s_add_u32 m0, s36, 16384
  s_add_u32 s38, s35, 196608
  buffer_load_dwordx4 v159, s[12:15], s38 offen lds
  s_add_u32 m0, s36, 17408
  s_add_u32 s38, s35, 229376
  buffer_load_dwordx4 v159, s[12:15], s38 offen lds
  s_lshl_b32 s35, s3, 6
  s_add_u32 s35, s35, s42
  s_add_u32 s36, s59, s43
  s_add_u32 m0, s36, 2048
  s_add_u32 s38, s35, 32768
  buffer_load_dwordx4 v158, s[8:11], s38 offen lds
  s_add_u32 m0, s36, 3072
  s_add_u32 s38, s35, 49152
  buffer_load_dwordx4 v158, s[8:11], s38 offen lds
  s_add_u32 m0, s36, 4096
  s_add_u32 s38, s35, 65536
  buffer_load_dwordx4 v158, s[8:11], s38 offen lds
  v_mfma_f32_32x32x16_bf16 v[0:15], v[64:67], v[136:139], v[0:15]
  ds_read_b128 v[96:99], v154
  ds_read_b64_tr_b16 v[104:105], v144 offset:0
  ds_read_b64_tr_b16 v[106:107], v144 offset:1024
  v_mfma_f32_32x32x16_bf16 v[16:31], v[68:71], v[136:139], v[16:31]
  ds_read_b64_tr_b16 v[108:109], v145 offset:0
  ds_read_b64_tr_b16 v[110:111], v145 offset:1024
  ds_read_b64_tr_b16 v[112:113], v146 offset:0
  v_mfma_f32_32x32x16_bf16 v[32:47], v[72:75], v[136:139], v[32:47]
  ds_read_b64_tr_b16 v[114:115], v146 offset:1024
  ds_read_b64_tr_b16 v[116:117], v147 offset:0
  ds_read_b64_tr_b16 v[118:119], v147 offset:1024
  v_mfma_f32_32x32x16_bf16 v[48:63], v[76:79], v[136:139], v[48:63]
  ds_read_b128 v[100:103], v155
  ds_read_b64_tr_b16 v[120:121], v144 offset:4096
  ds_read_b64_tr_b16 v[122:123], v144 offset:5120
  v_mfma_f32_32x32x16_bf16 v[0:15], v[80:83], v[140:143], v[0:15]
  s_waitcnt lgkmcnt(9)
  ds_read_b64_tr_b16 v[124:125], v145 offset:4096
  ds_read_b64_tr_b16 v[126:127], v145 offset:5120
  ds_read_b64_tr_b16 v[128:129], v146 offset:4096
  v_mfma_f32_32x32x16_bf16 v[16:31], v[84:87], v[140:143], v[16:31]
  s_waitcnt lgkmcnt(9)
  ds_read_b64_tr_b16 v[130:131], v146 offset:5120
  ds_read_b64_tr_b16 v[132:133], v147 offset:4096
  ds_read_b64_tr_b16 v[134:135], v147 offset:5120
  v_mfma_f32_32x32x16_bf16 v[32:47], v[88:91], v[140:143], v[32:47]
  v_mfma_f32_32x32x16_bf16 v[48:63], v[92:95], v[140:143], v[48:63]
  s_add_u32 s3, s3, 1
  s_and_b32 s3, s3, 15
  s_mov_b32 s59, s61
  s_add_u32 s61, s61, 32768
  s_cmp_eq_u32 s61, 163840
  s_cselect_b32 s61, 65536, s61
  s_waitcnt lgkmcnt(0)
  s_add_u32 s39, s39, 1
  s_cmp_lt_u32 s39, 6
  s_cbranch_scc1 concat_heads__gqa_block_cached__gqa_block_cached__near_ridge_kernel_ql3
  s_branch concat_heads__gqa_block_cached__gqa_block_cached__near_ridge_kernel_qtail
concat_heads__gqa_block_cached__gqa_block_cached__near_ridge_kernel_cls4:
  s_add_u32 s3, s3, 1
  s_and_b32 s3, s3, 15
  s_add_u32 s3, s3, 1
  s_and_b32 s3, s3, 15
  s_add_u32 s3, s3, 1
  s_and_b32 s3, s3, 15
  v_lshrrev_b32 v1, 5, v162
  v_bfe_u32 v2, v162, 2, 2
  v_lshl_add_u32 v3, v1, 3, v2
  v_lshlrev_b32 v3, 8, v3
  v_lshl_add_u32 v3, v2, 6, v3
  v_bfe_u32 v4, v162, 4, 1
  v_lshl_add_u32 v3, v4, 5, v3
  v_and_b32 v4, 1, v162
  v_lshl_add_u32 v3, v4, 4, v3
  v_bfe_u32 v4, v162, 1, 1
  v_lshl_add_u32 v3, v4, 3, v3
  s_add_u32 s36, s40, 16384
  v_add_u32 v149, s36, v3
  v_and_b32 v2, 0x13, v162
  v_and_b32 v3, 4, v162
  v_lshl_or_b32 v2, v3, 1, v2
  v_and_b32 v3, 8, v162
  v_lshrrev_b32 v3, 1, v3
  v_or_b32 v2, v2, v3
  v_bfe_u32 v3, v2, 1, 3
  v_xor_b32 v3, v3, v1
  v_lshlrev_b32 v3, 4, v3
  v_lshl_add_u32 v3, v2, 7, v3
  v_add_u32 v148, s40, v3
  v_and_b32 v2, 31, v162
  v_bfe_u32 v3, v162, 2, 2
  v_xor_b32 v3, v3, v1
  v_lshlrev_b32 v3, 4, v3
  v_lshl_add_u32 v3, v2, 6, v3
  s_lshl_b32 s35, s30, 11
  v_add_u32 v160, s35, v3
  v_lshlrev_b32 v161, 4, v162
  v_mov_b32 v0, 0
  v_mov_b32 v1, 0
  v_mov_b32 v2, 0
  v_mov_b32 v3, 0
  v_mov_b32 v4, 0
  v_mov_b32 v5, 0
  v_mov_b32 v6, 0
  v_mov_b32 v7, 0
  v_mov_b32 v8, 0
  v_mov_b32 v9, 0
  v_mov_b32 v10, 0
  v_mov_b32 v11, 0
  v_mov_b32 v12, 0
  v_mov_b32 v13, 0
  v_mov_b32 v14, 0
  v_mov_b32 v15, 0
  v_mov_b32 v16, 0
  v_mov_b32 v17, 0
  v_mov_b32 v18, 0
  v_mov_b32 v19, 0
  v_mov_b32 v20, 0
  v_mov_b32 v21, 0
  v_mov_b32 v22, 0
  v_mov_b32 v23, 0
  v_mov_b32 v24, 0
  v_mov_b32 v25, 0
  v_mov_b32 v26, 0
  v_mov_b32 v27, 0
  v_mov_b32 v28, 0
  v_mov_b32 v29, 0
  v_mov_b32 v30, 0
  v_mov_b32 v31, 0
  v_mov_b32 v32, 0
  v_mov_b32 v33, 0
  v_mov_b32 v34, 0
  v_mov_b32 v35, 0
  v_mov_b32 v36, 0
  v_mov_b32 v37, 0
  v_mov_b32 v38, 0
  v_mov_b32 v39, 0
  v_mov_b32 v40, 0
  v_mov_b32 v41, 0
  v_mov_b32 v42, 0
  v_mov_b32 v43, 0
  v_mov_b32 v44, 0
  v_mov_b32 v45, 0
  v_mov_b32 v46, 0
  v_mov_b32 v47, 0
  v_mov_b32 v48, 0
  v_mov_b32 v49, 0
  v_mov_b32 v50, 0
  v_mov_b32 v51, 0
  v_mov_b32 v52, 0
  v_mov_b32 v53, 0
  v_mov_b32 v54, 0
  v_mov_b32 v55, 0
  v_mov_b32 v56, 0
  v_mov_b32 v57, 0
  v_mov_b32 v58, 0
  v_mov_b32 v59, 0
  v_mov_b32 v60, 0
  v_mov_b32 v61, 0
  v_mov_b32 v62, 0
  v_mov_b32 v63, 0
  s_barrier
  v_add_u32 v144, 124928, v149
  v_add_u32 v154, 131072, v160
  v_xor_b32 v145, 64, v144
  v_xor_b32 v146, 128, v144
  v_xor_b32 v147, 192, v144
  v_xor_b32 v155, 32, v154
  ds_read_b128 v[96:99], v154
  ds_read_b64_tr_b16 v[104:105], v144 offset:0
  ds_read_b64_tr_b16 v[106:107], v144 offset:1024
  ds_read_b64_tr_b16 v[108:109], v145 offset:0
  ds_read_b64_tr_b16 v[110:111], v145 offset:1024
  ds_read_b64_tr_b16 v[112:113], v146 offset:0
  ds_read_b64_tr_b16 v[114:115], v146 offset:1024
  ds_read_b64_tr_b16 v[116:117], v147 offset:0
  ds_read_b64_tr_b16 v[118:119], v147 offset:1024
  ds_read_b128 v[100:103], v155
  ds_read_b64_tr_b16 v[120:121], v144 offset:4096
  ds_read_b64_tr_b16 v[122:123], v144 offset:5120
  ds_read_b64_tr_b16 v[124:125], v145 offset:4096
  ds_read_b64_tr_b16 v[126:127], v145 offset:5120
  s_waitcnt lgkmcnt(8)
  ds_read_b64_tr_b16 v[128:129], v146 offset:4096
  ds_read_b64_tr_b16 v[130:131], v146 offset:5120
  ds_read_b64_tr_b16 v[132:133], v147 offset:4096
  ds_read_b64_tr_b16 v[134:135], v147 offset:5120
  s_waitcnt lgkmcnt(0)
  s_mov_b32 s59, 131072
  s_mov_b32 s61, 65536
  s_mov_b32 s39, 0
  s_mov_b32 s4, s58
  s_mov_b32 s5, 0
concat_heads__gqa_block_cached__gqa_block_cached__near_ridge_kernel_ql4:
  s_barrier
  s_add_u32 s37, s61, 4294961152
  v_add_u32 v144, s37, v149
  v_add_u32 v154, s61, v160
  v_xor_b32 v145, 64, v144
  v_xor_b32 v146, 128, v144
  v_xor_b32 v147, 192, v144
  v_xor_b32 v155, 32, v154
  v_mfma_f32_32x32x16_bf16 v[0:15], v[104:107], v[96:99], v[0:15]
  ds_read_b128 v[136:139], v154
  ds_read_b64_tr_b16 v[64:65], v144 offset:0
  ds_read_b64_tr_b16 v[66:67], v144 offset:1024
  v_mfma_f32_32x32x16_bf16 v[16:31], v[108:111], v[96:99], v[16:31]
  ds_read_b64_tr_b16 v[68:69], v145 offset:0
  ds_read_b64_tr_b16 v[70:71], v145 offset:1024
  ds_read_b64_tr_b16 v[72:73], v146 offset:0
  v_mfma_f32_32x32x16_bf16 v[32:47], v[112:115], v[96:99], v[32:47]
  ds_read_b64_tr_b16 v[74:75], v146 offset:1024
  ds_read_b64_tr_b16 v[76:77], v147 offset:0
  ds_read_b64_tr_b16 v[78:79], v147 offset:1024
  v_mfma_f32_32x32x16_bf16 v[48:63], v[116:119], v[96:99], v[48:63]
  ds_read_b128 v[140:143], v155
  ds_read_b64_tr_b16 v[80:81], v144 offset:4096
  ds_read_b64_tr_b16 v[82:83], v144 offset:5120
  v_mfma_f32_32x32x16_bf16 v[0:15], v[120:123], v[100:103], v[0:15]
  s_waitcnt lgkmcnt(9)
  ds_read_b64_tr_b16 v[84:85], v145 offset:4096
  ds_read_b64_tr_b16 v[86:87], v145 offset:5120
  ds_read_b64_tr_b16 v[88:89], v146 offset:4096
  v_mfma_f32_32x32x16_bf16 v[16:31], v[124:127], v[100:103], v[16:31]
  s_waitcnt lgkmcnt(9)
  ds_read_b64_tr_b16 v[90:91], v146 offset:5120
  ds_read_b64_tr_b16 v[92:93], v147 offset:4096
  ds_read_b64_tr_b16 v[94:95], v147 offset:5120
  v_mfma_f32_32x32x16_bf16 v[32:47], v[128:131], v[100:103], v[32:47]
  v_mfma_f32_32x32x16_bf16 v[48:63], v[132:135], v[100:103], v[48:63]
  s_add_u32 s3, s3, 1
  s_and_b32 s3, s3, 15
  s_mov_b32 s59, s61
  s_add_u32 s61, s61, 32768
  s_cmp_eq_u32 s61, 163840
  s_cselect_b32 s61, 65536, s61
  s_waitcnt lgkmcnt(0)
  s_barrier
  s_add_u32 s37, s61, 4294961152
  v_add_u32 v144, s37, v149
  v_add_u32 v154, s61, v160
  v_xor_b32 v145, 64, v144
  v_xor_b32 v146, 128, v144
  v_xor_b32 v147, 192, v144
  v_xor_b32 v155, 32, v154
  v_mfma_f32_32x32x16_bf16 v[0:15], v[64:67], v[136:139], v[0:15]
  ds_read_b128 v[96:99], v154
  ds_read_b64_tr_b16 v[104:105], v144 offset:0
  ds_read_b64_tr_b16 v[106:107], v144 offset:1024
  v_mfma_f32_32x32x16_bf16 v[16:31], v[68:71], v[136:139], v[16:31]
  ds_read_b64_tr_b16 v[108:109], v145 offset:0
  ds_read_b64_tr_b16 v[110:111], v145 offset:1024
  ds_read_b64_tr_b16 v[112:113], v146 offset:0
  v_mfma_f32_32x32x16_bf16 v[32:47], v[72:75], v[136:139], v[32:47]
  ds_read_b64_tr_b16 v[114:115], v146 offset:1024
  ds_read_b64_tr_b16 v[116:117], v147 offset:0
  ds_read_b64_tr_b16 v[118:119], v147 offset:1024
  v_mfma_f32_32x32x16_bf16 v[48:63], v[76:79], v[136:139], v[48:63]
  ds_read_b128 v[100:103], v155
  ds_read_b64_tr_b16 v[120:121], v144 offset:4096
  ds_read_b64_tr_b16 v[122:123], v144 offset:5120
  v_mfma_f32_32x32x16_bf16 v[0:15], v[80:83], v[140:143], v[0:15]
  s_waitcnt lgkmcnt(9)
  ds_read_b64_tr_b16 v[124:125], v145 offset:4096
  ds_read_b64_tr_b16 v[126:127], v145 offset:5120
  ds_read_b64_tr_b16 v[128:129], v146 offset:4096
  v_mfma_f32_32x32x16_bf16 v[16:31], v[84:87], v[140:143], v[16:31]
  s_waitcnt lgkmcnt(9)
  ds_read_b64_tr_b16 v[130:131], v146 offset:5120
  ds_read_b64_tr_b16 v[132:133], v147 offset:4096
  ds_read_b64_tr_b16 v[134:135], v147 offset:5120
  v_mfma_f32_32x32x16_bf16 v[32:47], v[88:91], v[140:143], v[32:47]
  v_mfma_f32_32x32x16_bf16 v[48:63], v[92:95], v[140:143], v[48:63]
  s_add_u32 s3, s3, 1
  s_and_b32 s3, s3, 15
  s_mov_b32 s59, s61
  s_add_u32 s61, s61, 32768
  s_cmp_eq_u32 s61, 163840
  s_cselect_b32 s61, 65536, s61
  s_waitcnt lgkmcnt(0)
  s_add_u32 s39, s39, 1
  s_cmp_lt_u32 s39, 6
  s_cbranch_scc1 concat_heads__gqa_block_cached__gqa_block_cached__near_ridge_kernel_ql4
concat_heads__gqa_block_cached__gqa_block_cached__near_ridge_kernel_qtail:
  s_cmp_eq_u32 s30, 1
  s_cbranch_scc0 concat_heads__gqa_block_cached__gqa_block_cached__near_ridge_kernel_c1_3
  s_waitcnt vmcnt(6)
concat_heads__gqa_block_cached__gqa_block_cached__near_ridge_kernel_c1_3:
  s_cmp_eq_u32 s30, 3
  s_cbranch_scc0 concat_heads__gqa_block_cached__gqa_block_cached__near_ridge_kernel_c3_4
  s_waitcnt vmcnt(7)
concat_heads__gqa_block_cached__gqa_block_cached__near_ridge_kernel_c3_4:
  s_barrier
  v_add_u32 v144, 59392, v149
  v_add_u32 v154, 65536, v160
  v_xor_b32 v145, 64, v144
  v_xor_b32 v146, 128, v144
  v_xor_b32 v147, 192, v144
  v_xor_b32 v155, 32, v154
  s_cmp_eq_u32 s30, 1
  s_cbranch_scc0 concat_heads__gqa_block_cached__gqa_block_cached__near_ridge_kernel_c1_5
  s_lshl_b32 s35, s3, 18
  s_add_u32 s35, s35, s31
  s_add_u32 s36, s40, 131072
  s_add_u32 m0, s36, 10240
  s_add_u32 s38, s35, 0
  buffer_load_dwordx4 v159, s[12:15], s38 offen lds
  s_add_u32 m0, s36, 11264
  s_add_u32 s38, s35, 32768
  buffer_load_dwordx4 v159, s[12:15], s38 offen lds
  s_add_u32 m0, s36, 12288
  s_add_u32 s38, s35, 65536
  buffer_load_dwordx4 v159, s[12:15], s38 offen lds
  s_add_u32 m0, s36, 13312
  s_add_u32 s38, s35, 98304
  buffer_load_dwordx4 v159, s[12:15], s38 offen lds
  s_lshl_b32 s35, s3, 6
  s_add_u32 s35, s35, s42
  s_add_u32 s36, s43, 131072
  s_add_u32 m0, s36, 0
  s_add_u32 s38, s35, 0
  buffer_load_dwordx4 v158, s[8:11], s38 offen lds
  s_add_u32 m0, s36, 1024
  s_add_u32 s38, s35, 16384
  buffer_load_dwordx4 v158, s[8:11], s38 offen lds
concat_heads__gqa_block_cached__gqa_block_cached__near_ridge_kernel_c1_5:
  s_cmp_eq_u32 s30, 3
  s_cbranch_scc0 concat_heads__gqa_block_cached__gqa_block_cached__near_ridge_kernel_c3_6
  s_lshl_b32 s35, s3, 18
  s_add_u32 s35, s35, s31
  s_add_u32 s36, s40, 131072
  s_add_u32 m0, s36, 14336
  s_add_u32 s38, s35, 131072
  buffer_load_dwordx4 v159, s[12:15], s38 offen lds
  s_add_u32 m0, s36, 15360
  s_add_u32 s38, s35, 163840
  buffer_load_dwordx4 v159, s[12:15], s38 offen lds
  s_add_u32 m0, s36, 16384
  s_add_u32 s38, s35, 196608
  buffer_load_dwordx4 v159, s[12:15], s38 offen lds
  s_add_u32 m0, s36, 17408
  s_add_u32 s38, s35, 229376
  buffer_load_dwordx4 v159, s[12:15], s38 offen lds
  s_lshl_b32 s35, s3, 6
  s_add_u32 s35, s35, s42
  s_add_u32 s36, s43, 131072
  s_add_u32 m0, s36, 2048
  s_add_u32 s38, s35, 32768
  buffer_load_dwordx4 v158, s[8:11], s38 offen lds
  s_add_u32 m0, s36, 3072
  s_add_u32 s38, s35, 49152
  buffer_load_dwordx4 v158, s[8:11], s38 offen lds
  s_add_u32 m0, s36, 4096
  s_add_u32 s38, s35, 65536
  buffer_load_dwordx4 v158, s[8:11], s38 offen lds
concat_heads__gqa_block_cached__gqa_block_cached__near_ridge_kernel_c3_6:
  v_mfma_f32_32x32x16_bf16 v[0:15], v[104:107], v[96:99], v[0:15]
  ds_read_b128 v[136:139], v154
  ds_read_b64_tr_b16 v[64:65], v144 offset:0
  ds_read_b64_tr_b16 v[66:67], v144 offset:1024
  v_mfma_f32_32x32x16_bf16 v[16:31], v[108:111], v[96:99], v[16:31]
  ds_read_b64_tr_b16 v[68:69], v145 offset:0
  ds_read_b64_tr_b16 v[70:71], v145 offset:1024
  ds_read_b64_tr_b16 v[72:73], v146 offset:0
  v_mfma_f32_32x32x16_bf16 v[32:47], v[112:115], v[96:99], v[32:47]
  ds_read_b64_tr_b16 v[74:75], v146 offset:1024
  ds_read_b64_tr_b16 v[76:77], v147 offset:0
  ds_read_b64_tr_b16 v[78:79], v147 offset:1024
  v_mfma_f32_32x32x16_bf16 v[48:63], v[116:119], v[96:99], v[48:63]
  ds_read_b128 v[140:143], v155
  ds_read_b64_tr_b16 v[80:81], v144 offset:4096
  ds_read_b64_tr_b16 v[82:83], v144 offset:5120
  v_mfma_f32_32x32x16_bf16 v[0:15], v[120:123], v[100:103], v[0:15]
  s_waitcnt lgkmcnt(9)
  ds_read_b64_tr_b16 v[84:85], v145 offset:4096
  ds_read_b64_tr_b16 v[86:87], v145 offset:5120
  ds_read_b64_tr_b16 v[88:89], v146 offset:4096
  v_mfma_f32_32x32x16_bf16 v[16:31], v[124:127], v[100:103], v[16:31]
  s_waitcnt lgkmcnt(9)
  ds_read_b64_tr_b16 v[90:91], v146 offset:5120
  ds_read_b64_tr_b16 v[92:93], v147 offset:4096
  ds_read_b64_tr_b16 v[94:95], v147 offset:5120
  v_mfma_f32_32x32x16_bf16 v[32:47], v[128:131], v[100:103], v[32:47]
  v_mfma_f32_32x32x16_bf16 v[48:63], v[132:135], v[100:103], v[48:63]
  s_waitcnt lgkmcnt(0)
  s_cmp_eq_u32 s30, 1
  s_cbranch_scc0 concat_heads__gqa_block_cached__gqa_block_cached__near_ridge_kernel_c1_7
  s_waitcnt vmcnt(6)
concat_heads__gqa_block_cached__gqa_block_cached__near_ridge_kernel_c1_7:
  s_cmp_eq_u32 s30, 3
  s_cbranch_scc0 concat_heads__gqa_block_cached__gqa_block_cached__near_ridge_kernel_c3_8
  s_waitcnt vmcnt(7)
concat_heads__gqa_block_cached__gqa_block_cached__near_ridge_kernel_c3_8:
  s_barrier
  v_add_u32 v144, 92160, v149
  v_add_u32 v154, 98304, v160
  v_xor_b32 v145, 64, v144
  v_xor_b32 v146, 128, v144
  v_xor_b32 v147, 192, v144
  v_xor_b32 v155, 32, v154
  v_mfma_f32_32x32x16_bf16 v[0:15], v[64:67], v[136:139], v[0:15]
  ds_read_b128 v[96:99], v154
  ds_read_b64_tr_b16 v[104:105], v144 offset:0
  ds_read_b64_tr_b16 v[106:107], v144 offset:1024
  v_mfma_f32_32x32x16_bf16 v[16:31], v[68:71], v[136:139], v[16:31]
  ds_read_b64_tr_b16 v[108:109], v145 offset:0
  ds_read_b64_tr_b16 v[110:111], v145 offset:1024
  ds_read_b64_tr_b16 v[112:113], v146 offset:0
  v_mfma_f32_32x32x16_bf16 v[32:47], v[72:75], v[136:139], v[32:47]
  ds_read_b64_tr_b16 v[114:115], v146 offset:1024
  ds_read_b64_tr_b16 v[116:117], v147 offset:0
  ds_read_b64_tr_b16 v[118:119], v147 offset:1024
  v_mfma_f32_32x32x16_bf16 v[48:63], v[76:79], v[136:139], v[48:63]
  ds_read_b128 v[100:103], v155
  ds_read_b64_tr_b16 v[120:121], v144 offset:4096
  ds_read_b64_tr_b16 v[122:123], v144 offset:5120
  v_mfma_f32_32x32x16_bf16 v[0:15], v[80:83], v[140:143], v[0:15]
  s_waitcnt lgkmcnt(9)
  ds_read_b64_tr_b16 v[124:125], v145 offset:4096
  ds_read_b64_tr_b16 v[126:127], v145 offset:5120
  ds_read_b64_tr_b16 v[128:129], v146 offset:4096
  v_mfma_f32_32x32x16_bf16 v[16:31], v[84:87], v[140:143], v[16:31]
  s_waitcnt lgkmcnt(9)
  ds_read_b64_tr_b16 v[130:131], v146 offset:5120
  ds_read_b64_tr_b16 v[132:133], v147 offset:4096
  ds_read_b64_tr_b16 v[134:135], v147 offset:5120
  v_mfma_f32_32x32x16_bf16 v[32:47], v[88:91], v[140:143], v[32:47]
  v_mfma_f32_32x32x16_bf16 v[48:63], v[92:95], v[140:143], v[48:63]
  s_cmp_lt_u32 s28, 4
  s_cbranch_scc0 concat_heads__gqa_block_cached__gqa_block_cached__near_ridge_kernel_lo4_9
  s_add_u32 s60, s58, 16384
  s_and_b32 s60, s60, 0x1ffff
  s_add_u32 s35, s32, 65536
  s_add_u32 s36, s60, s32
  s_add_u32 s37, s60, 0
  s_add_u32 m0, s35, 0
  s_add_u32 s38, s37, 0
  buffer_load_dwordx4 v156, s[16:19], s38 offen nt lds
  s_add_u32 m0, s35, 4096
  s_add_u32 s38, s37, 128
  buffer_load_dwordx4 v156, s[16:19], s38 offen nt lds
  s_add_u32 m0, s35, 8192
  s_add_u32 s38, s37, 131072
  buffer_load_dwordx4 v156, s[16:19], s38 offen nt lds
  s_add_u32 m0, s35, 12288
  s_add_u32 s38, s37, 131200
  buffer_load_dwordx4 v156, s[16:19], s38 offen nt lds
  s_add_u32 m0, s35, 16384
  s_add_u32 s38, s36, 0
  buffer_load_dwordx4 v157, s[20:23], s38 offen nt lds
  s_add_u32 m0, s35, 20480
  s_add_u32 s38, s36, 4096
  buffer_load_dwordx4 v157, s[20:23], s38 offen nt lds
  s_add_u32 m0, s35, 24576
  s_add_u32 s38, s36, 131072
  buffer_load_dwordx4 v157, s[20:23], s38 offen nt lds
  s_add_u32 m0, s35, 28672
  s_add_u32 s38, s36, 135168
  buffer_load_dwordx4 v157, s[20:23], s38 offen nt lds
concat_heads__gqa_block_cached__gqa_block_cached__near_ridge_kernel_lo4_9:
  s_waitcnt lgkmcnt(0)
  s_cmp_eq_u32 s30, 1
  s_cbranch_scc0 concat_heads__gqa_block_cached__gqa_block_cached__near_ridge_kernel_c1_10
  s_waitcnt vmcnt(8)
concat_heads__gqa_block_cached__gqa_block_cached__near_ridge_kernel_c1_10:
  s_cmp_eq_u32 s30, 3
  s_cbranch_scc0 concat_heads__gqa_block_cached__gqa_block_cached__near_ridge_kernel_c3_11
  s_waitcnt vmcnt(0)
concat_heads__gqa_block_cached__gqa_block_cached__near_ridge_kernel_c3_11:
  s_barrier
  v_add_u32 v144, 124928, v149
  v_add_u32 v154, 131072, v160
  v_xor_b32 v145, 64, v144
  v_xor_b32 v146, 128, v144
  v_xor_b32 v147, 192, v144
  v_xor_b32 v155, 32, v154
  v_mfma_f32_32x32x16_bf16 v[0:15], v[104:107], v[96:99], v[0:15]
  ds_read_b128 v[136:139], v154
  ds_read_b64_tr_b16 v[64:65], v144 offset:0
  ds_read_b64_tr_b16 v[66:67], v144 offset:1024
  v_mfma_f32_32x32x16_bf16 v[16:31], v[108:111], v[96:99], v[16:31]
  ds_read_b64_tr_b16 v[68:69], v145 offset:0
  ds_read_b64_tr_b16 v[70:71], v145 offset:1024
  ds_read_b64_tr_b16 v[72:73], v146 offset:0
  v_mfma_f32_32x32x16_bf16 v[32:47], v[112:115], v[96:99], v[32:47]
  ds_read_b64_tr_b16 v[74:75], v146 offset:1024
  ds_read_b64_tr_b16 v[76:77], v147 offset:0
  ds_read_b64_tr_b16 v[78:79], v147 offset:1024
  v_mfma_f32_32x32x16_bf16 v[48:63], v[116:119], v[96:99], v[48:63]
  ds_read_b128 v[140:143], v155
  ds_read_b64_tr_b16 v[80:81], v144 offset:4096
  ds_read_b64_tr_b16 v[82:83], v144 offset:5120
  v_mfma_f32_32x32x16_bf16 v[0:15], v[120:123], v[100:103], v[0:15]
  s_waitcnt lgkmcnt(9)
  ds_read_b64_tr_b16 v[84:85], v145 offset:4096
  ds_read_b64_tr_b16 v[86:87], v145 offset:5120
  ds_read_b64_tr_b16 v[88:89], v146 offset:4096
  v_mfma_f32_32x32x16_bf16 v[16:31], v[124:127], v[100:103], v[16:31]
  s_waitcnt lgkmcnt(9)
  ds_read_b64_tr_b16 v[90:91], v146 offset:5120
  ds_read_b64_tr_b16 v[92:93], v147 offset:4096
  ds_read_b64_tr_b16 v[94:95], v147 offset:5120
  v_mfma_f32_32x32x16_bf16 v[32:47], v[128:131], v[100:103], v[32:47]
  v_mfma_f32_32x32x16_bf16 v[48:63], v[132:135], v[100:103], v[48:63]
  s_cmp_lt_u32 s28, 4
  s_cbranch_scc0 concat_heads__gqa_block_cached__gqa_block_cached__near_ridge_kernel_lo4_12
  s_add_u32 s60, s58, 24576
  s_and_b32 s60, s60, 0x1ffff
  s_add_u32 s35, s32, 98304
  s_add_u32 s36, s60, s32
  s_add_u32 s37, s60, 0
  s_add_u32 m0, s35, 0
  s_add_u32 s38, s37, 0
  buffer_load_dwordx4 v156, s[16:19], s38 offen nt lds
  s_add_u32 m0, s35, 4096
  s_add_u32 s38, s37, 128
  buffer_load_dwordx4 v156, s[16:19], s38 offen nt lds
  s_add_u32 m0, s35, 8192
  s_add_u32 s38, s37, 131072
  buffer_load_dwordx4 v156, s[16:19], s38 offen nt lds
  s_add_u32 m0, s35, 12288
  s_add_u32 s38, s37, 131200
  buffer_load_dwordx4 v156, s[16:19], s38 offen nt lds
  s_add_u32 m0, s35, 16384
  s_add_u32 s38, s36, 0
  buffer_load_dwordx4 v157, s[20:23], s38 offen nt lds
  s_add_u32 m0, s35, 20480
  s_add_u32 s38, s36, 4096
  buffer_load_dwordx4 v157, s[20:23], s38 offen nt lds
  s_add_u32 m0, s35, 24576
  s_add_u32 s38, s36, 131072
  buffer_load_dwordx4 v157, s[20:23], s38 offen nt lds
  s_add_u32 m0, s35, 28672
  s_add_u32 s38, s36, 135168
  buffer_load_dwordx4 v157, s[20:23], s38 offen nt lds
concat_heads__gqa_block_cached__gqa_block_cached__near_ridge_kernel_lo4_12:
  s_waitcnt lgkmcnt(0)
  s_barrier
  v_mfma_f32_32x32x16_bf16 v[0:15], v[64:67], v[136:139], v[0:15]
  v_mfma_f32_32x32x16_bf16 v[16:31], v[68:71], v[136:139], v[16:31]
  v_mfma_f32_32x32x16_bf16 v[32:47], v[72:75], v[136:139], v[32:47]
  v_mfma_f32_32x32x16_bf16 v[48:63], v[76:79], v[136:139], v[48:63]
  v_mfma_f32_32x32x16_bf16 v[0:15], v[80:83], v[140:143], v[0:15]
  v_mfma_f32_32x32x16_bf16 v[16:31], v[84:87], v[140:143], v[16:31]
  v_mfma_f32_32x32x16_bf16 v[32:47], v[88:91], v[140:143], v[32:47]
  v_mfma_f32_32x32x16_bf16 v[48:63], v[92:95], v[140:143], v[48:63]
  s_waitcnt lgkmcnt(0)
  s_lshl_b32 s35, s100, 8
  s_add_u32 s8, s62, s35
  s_addc_u32 s9, s63, 0
  s_mov_b32 s10, 0
  s_mov_b32 s11, 0x00020000
  s_sub_u32 s10, 4194304, s35
  v_lshrrev_b32 v154, 4, v162
  v_mul_u32_u24 v154, 768, v154
  v_add_u32 v159, v154, v157
  s_nop 11
  s_mov_b32 s35, 0x3e0293ee
  v_mov_b32 v152, s35
  s_nop 0
  v_mul_f32 v0, s35, v0
  v_mul_f32 v1, s35, v1
  v_mul_f32 v2, s35, v2
  v_mul_f32 v3, s35, v3
  v_mul_f32 v4, s35, v4
  v_mul_f32 v5, s35, v5
  v_mul_f32 v6, s35, v6
  v_mul_f32 v7, s35, v7
  v_mul_f32 v8, s35, v8
  v_mul_f32 v9, s35, v9
  v_mul_f32 v10, s35, v10
  v_mul_f32 v11, s35, v11
  v_mul_f32 v12, s35, v12
  v_mul_f32 v13, s35, v13
  v_mul_f32 v14, s35, v14
  v_mul_f32 v15, s35, v15
  v_mul_f32 v16, s35, v16
  v_mul_f32 v17, s35, v17
  v_mul_f32 v18, s35, v18
  v_mul_f32 v19, s35, v19
  v_mul_f32 v20, s35, v20
  v_mul_f32 v21, s35, v21
  v_mul_f32 v22, s35, v22
  v_mul_f32 v23, s35, v23
  v_mul_f32 v24, s35, v24
  v_mul_f32 v25, s35, v25
  v_mul_f32 v26, s35, v26
  v_mul_f32 v27, s35, v27
  v_mul_f32 v28, s35, v28
  v_mul_f32 v29, s35, v29
  v_mul_f32 v30, s35, v30
  v_mul_f32 v31, s35, v31
  v_mul_f32 v32, s35, v32
  v_mul_f32 v33, s35, v33
  v_mul_f32 v34, s35, v34
  v_mul_f32 v35, s35, v35
  v_mul_f32 v36, s35, v36
  v_mul_f32 v37, s35, v37
  v_mul_f32 v38, s35, v38
  v_mul_f32 v39, s35, v39
  v_mul_f32 v40, s35, v40
  v_mul_f32 v41, s35, v41
  v_mul_f32 v42, s35, v42
  v_mul_f32 v43, s35, v43
  v_mul_f32 v44, s35, v44
  v_mul_f32 v45, s35, v45
  v_mul_f32 v46, s35, v46
  v_mul_f32 v47, s35, v47
  v_mul_f32 v48, s35, v48
  v_mul_f32 v49, s35, v49
  v_mul_f32 v50, s35, v50
  v_mul_f32 v51, s35, v51
  v_mul_f32 v52, s35, v52
  v_mul_f32 v53, s35, v53
  v_mul_f32 v54, s35, v54
  v_mul_f32 v55, s35, v55
  v_mul_f32 v56, s35, v56
  v_mul_f32 v57, s35, v57
  v_mul_f32 v58, s35, v58
  v_mul_f32 v59, s35, v59
  v_mul_f32 v60, s35, v60
  v_mul_f32 v61, s35, v61
  v_mul_f32 v62, s35, v62
  v_mul_f32 v63, s35, v63
  v_cvt_pk_bf16_f32 v64, v0, v1
  v_cvt_pk_bf16_f32 v65, v2, v3
  v_cvt_pk_bf16_f32 v66, v4, v5
  v_cvt_pk_bf16_f32 v67, v6, v7
  v_cvt_pk_bf16_f32 v68, v8, v9
  v_cvt_pk_bf16_f32 v69, v10, v11
  v_cvt_pk_bf16_f32 v70, v12, v13
  v_cvt_pk_bf16_f32 v71, v14, v15
  v_cvt_pk_bf16_f32 v72, v16, v17
  v_cvt_pk_bf16_f32 v73, v18, v19
  v_cvt_pk_bf16_f32 v74, v20, v21
  v_cvt_pk_bf16_f32 v75, v22, v23
  v_cvt_pk_bf16_f32 v76, v24, v25
  v_cvt_pk_bf16_f32 v77, v26, v27
  v_cvt_pk_bf16_f32 v78, v28, v29
  v_cvt_pk_bf16_f32 v79, v30, v31
  v_cvt_pk_bf16_f32 v80, v32, v33
  v_cvt_pk_bf16_f32 v81, v34, v35
  v_cvt_pk_bf16_f32 v82, v36, v37
  v_cvt_pk_bf16_f32 v83, v38, v39
  v_cvt_pk_bf16_f32 v84, v40, v41
  v_cvt_pk_bf16_f32 v85, v42, v43
  v_cvt_pk_bf16_f32 v86, v44, v45
  v_cvt_pk_bf16_f32 v87, v46, v47
  v_cvt_pk_bf16_f32 v88, v48, v49
  v_cvt_pk_bf16_f32 v89, v50, v51
  v_cvt_pk_bf16_f32 v90, v52, v53
  v_cvt_pk_bf16_f32 v91, v54, v55
  v_cvt_pk_bf16_f32 v92, v56, v57
  v_cvt_pk_bf16_f32 v93, v58, v59
  v_cvt_pk_bf16_f32 v94, v60, v61
  v_cvt_pk_bf16_f32 v95, v62, v63
  s_cmp_eq_u32 s30, 0
  s_cbranch_scc0 concat_heads__gqa_block_cached__gqa_block_cached__near_ridge_kernel_c0_13
  s_waitcnt vmcnt(32)
concat_heads__gqa_block_cached__gqa_block_cached__near_ridge_kernel_c0_13:
  s_barrier
  v_add_u32 v144, 0, v148
  v_xor_b32 v145, 32, v144
  v_xor_b32 v146, 64, v144
  v_xor_b32 v147, 96, v144
  ds_read_b128 v[128:131], v144 offset:0
  ds_read_b128 v[132:135], v145 offset:0
  ds_read_b128 v[136:139], v146 offset:0
  ds_read_b128 v[140:143], v147 offset:0
  s_cmp_eq_u32 s30, 0
  s_cbranch_scc0 concat_heads__gqa_block_cached__gqa_block_cached__near_ridge_kernel_c0_14
  s_waitcnt vmcnt(16)
concat_heads__gqa_block_cached__gqa_block_cached__near_ridge_kernel_c0_14:
  s_barrier
  s_setprio 1
  s_waitcnt lgkmcnt(3)
  v_mfma_f32_32x32x16_bf16 v[96:111], v[128:131], v[64:67], 0
  ds_read_b128 v[128:131], v144 offset:4096
  s_waitcnt lgkmcnt(3)
  v_mfma_f32_32x32x16_bf16 v[96:111], v[132:135], v[68:71], v[96:111]
  ds_read_b128 v[132:135], v145 offset:4096
  s_waitcnt lgkmcnt(3)
  v_mfma_f32_32x32x16_bf16 v[96:111], v[136:139], v[72:75], v[96:111]
  ds_read_b128 v[136:139], v146 offset:4096
  s_waitcnt lgkmcnt(3)
  v_mfma_f32_32x32x16_bf16 v[96:111], v[140:143], v[76:79], v[96:111]
  ds_read_b128 v[140:143], v147 offset:4096
  v_add_u32 v144, 0, v149
  v_xor_b32 v145, 64, v144
  v_xor_b32 v146, 128, v144
  v_xor_b32 v147, 192, v144
  s_waitcnt lgkmcnt(3)
  v_mfma_f32_32x32x16_bf16 v[96:111], v[128:131], v[80:83], v[96:111]
  ds_read_b64_tr_b16 v[128:129], v144 offset:0
  ds_read_b64_tr_b16 v[130:131], v144 offset:1024
  s_waitcnt lgkmcnt(4)
  v_mfma_f32_32x32x16_bf16 v[96:111], v[132:135], v[84:87], v[96:111]
  ds_read_b64_tr_b16 v[132:133], v145 offset:0
  ds_read_b64_tr_b16 v[134:135], v145 offset:1024
  s_waitcnt lgkmcnt(5)
  v_mfma_f32_32x32x16_bf16 v[96:111], v[136:139], v[88:91], v[96:111]
  ds_read_b64_tr_b16 v[136:137], v146 offset:0
  ds_read_b64_tr_b16 v[138:139], v146 offset:1024
  s_waitcnt lgkmcnt(6)
  v_mfma_f32_32x32x16_bf16 v[96:111], v[140:143], v[92:95], v[96:111]
  ds_read_b64_tr_b16 v[140:141], v147 offset:0
  ds_read_b64_tr_b16 v[142:143], v147 offset:1024
  s_setprio 0
  s_nop 9
  v_max3_f32 v152, v96, v97, v98
  v_max3_f32 v153, v99, v100, v101
  v_max3_f32 v152, v152, v102, v103
  v_max3_f32 v153, v153, v104, v105
  v_max3_f32 v152, v152, v106, v107
  v_max3_f32 v153, v153, v108, v109
  v_max3_f32 v152, v152, v110, v111
  v_max_f32 v152, v152, v153
  v_mov_b32 v153, v152
  s_nop 1
  v_permlane32_swap_b32 v152, v153
  s_nop 0
  v_max_f32 v152, v152, v153
  v_sub_f32 v96, v96, v152
  v_sub_f32 v97, v97, v152
  v_sub_f32 v98, v98, v152
  v_sub_f32 v99, v99, v152
  v_sub_f32 v100, v100, v152
  v_sub_f32 v101, v101, v152
  v_sub_f32 v102, v102, v152
  v_sub_f32 v103, v103, v152
  v_sub_f32 v104, v104, v152
  v_sub_f32 v105, v105, v152
  v_sub_f32 v106, v106, v152
  v_sub_f32 v107, v107, v152
  v_sub_f32 v108, v108, v152
  v_sub_f32 v109, v109, v152
  v_sub_f32 v110, v110, v152
  v_sub_f32 v111, v111, v152
  v_sub_f32 v112, 0, v152
  v_sub_f32 v113, 0, v152
  v_sub_f32 v114, 0, v152
  v_sub_f32 v115, 0, v152
  v_sub_f32 v116, 0, v152
  v_sub_f32 v117, 0, v152
  v_sub_f32 v118, 0, v152
  v_sub_f32 v119, 0, v152
  v_sub_f32 v120, 0, v152
  v_sub_f32 v121, 0, v152
  v_sub_f32 v122, 0, v152
  v_sub_f32 v123, 0, v152
  v_sub_f32 v124, 0, v152
  v_sub_f32 v125, 0, v152
  v_sub_f32 v126, 0, v152
  v_sub_f32 v127, 0, v152
  v_mov_b32 v150, 0
  v_mov_b32 v151, 0
  v_exp_f32 v96, v96
  v_exp_f32 v97, v97
  v_add_f32 v150, v150, v96
  v_exp_f32 v98, v98
  v_add_f32 v151, v151, v97
  v_exp_f32 v99, v99
  v_add_f32 v150, v150, v98
  v_exp_f32 v100, v100
  v_add_f32 v151, v151, v99
  v_exp_f32 v101, v101
  v_add_f32 v150, v150, v100
  v_exp_f32 v102, v102
  v_add_f32 v151, v151, v101
  v_exp_f32 v103, v103
  v_add_f32 v150, v150, v102
  v_cvt_pk_bf16_f32 v96, v96, v97
  v_add_f32 v151, v151, v103
  v_cvt_pk_bf16_f32 v97, v98, v99
  v_cvt_pk_bf16_f32 v98, v100, v101
  v_cvt_pk_bf16_f32 v99, v102, v103
  s_setprio 1
  s_nop 1
  s_waitcnt lgkmcnt(6)
  v_mfma_f32_32x32x16_bf16 v[0:15], v[128:131], v[96:99], 0
  ds_read_b64_tr_b16 v[128:129], v144 offset:4096
  ds_read_b64_tr_b16 v[130:131], v144 offset:5120
  v_exp_f32 v104, v104
  v_exp_f32 v105, v105
  v_add_f32 v150, v150, v104
  s_waitcnt lgkmcnt(6)
  v_mfma_f32_32x32x16_bf16 v[16:31], v[132:135], v[96:99], 0
  ds_read_b64_tr_b16 v[132:133], v145 offset:4096
  ds_read_b64_tr_b16 v[134:135], v145 offset:5120
  v_add_f32 v151, v151, v105
  v_exp_f32 v106, v106
  v_exp_f32 v107, v107
  v_add_f32 v150, v150, v106
  v_cvt_pk_bf16_f32 v100, v104, v105
  s_waitcnt lgkmcnt(6)
  v_mfma_f32_32x32x16_bf16 v[32:47], v[136:139], v[96:99], 0
  ds_read_b64_tr_b16 v[136:137], v146 offset:4096
  ds_read_b64_tr_b16 v[138:139], v146 offset:5120
  v_add_f32 v151, v151, v107
  v_exp_f32 v108, v108
  v_exp_f32 v109, v109
  v_add_f32 v150, v150, v108
  v_cvt_pk_bf16_f32 v101, v106, v107
  s_waitcnt lgkmcnt(6)
  v_mfma_f32_32x32x16_bf16 v[48:63], v[140:143], v[96:99], 0
  ds_read_b64_tr_b16 v[140:141], v147 offset:4096
  ds_read_b64_tr_b16 v[142:143], v147 offset:5120
  v_add_f32 v151, v151, v109
  v_exp_f32 v110, v110
  v_exp_f32 v111, v111
  v_add_f32 v150, v150, v110
  v_cvt_pk_bf16_f32 v102, v108, v109
  v_add_f32 v151, v151, v111
  v_cvt_pk_bf16_f32 v103, v110, v111
  v_add_u32 v144, 32768, v148
  v_xor_b32 v145, 32, v144
  v_xor_b32 v146, 64, v144
  v_xor_b32 v147, 96, v144
  s_waitcnt lgkmcnt(6)
  v_mfma_f32_32x32x16_bf16 v[0:15], v[128:131], v[100:103], v[0:15]
  ds_read_b128 v[128:131], v144 offset:0
  s_waitcnt lgkmcnt(5)
  v_mfma_f32_32x32x16_bf16 v[16:31], v[132:135], v[100:103], v[16:31]
  ds_read_b128 v[132:135], v145 offset:0
  s_waitcnt lgkmcnt(4)
  v_mfma_f32_32x32x16_bf16 v[32:47], v[136:139], v[100:103], v[32:47]
  ds_read_b128 v[136:139], v146 offset:0
  s_waitcnt lgkmcnt(3)
  v_mfma_f32_32x32x16_bf16 v[48:63], v[140:143], v[100:103], v[48:63]
  ds_read_b128 v[140:143], v147 offset:0
  s_cmp_lt_u32 s28, 4
  s_cbranch_scc0 concat_heads__gqa_block_cached__gqa_block_cached__near_ridge_kernel_lo4_15
  s_add_u32 s60, s58, 32768
  s_and_b32 s60, s60, 0x1ffff
  s_add_u32 s35, s32, 131072
  s_add_u32 s36, s60, s32
  s_add_u32 s37, s60, 0
  s_add_u32 m0, s35, 0
  s_add_u32 s38, s37, 0
  buffer_load_dwordx4 v156, s[16:19], s38 offen nt lds
  s_add_u32 m0, s35, 4096
  s_add_u32 s38, s37, 128
  buffer_load_dwordx4 v156, s[16:19], s38 offen nt lds
  s_add_u32 m0, s35, 8192
  s_add_u32 s38, s37, 131072
  buffer_load_dwordx4 v156, s[16:19], s38 offen nt lds
  s_add_u32 m0, s35, 12288
  s_add_u32 s38, s37, 131200
  buffer_load_dwordx4 v156, s[16:19], s38 offen nt lds
  s_add_u32 m0, s35, 16384
  s_add_u32 s38, s36, 0
  buffer_load_dwordx4 v157, s[20:23], s38 offen nt lds
  s_add_u32 m0, s35, 20480
  s_add_u32 s38, s36, 4096
  buffer_load_dwordx4 v157, s[20:23], s38 offen nt lds
  s_add_u32 m0, s35, 24576
  s_add_u32 s38, s36, 131072
  buffer_load_dwordx4 v157, s[20:23], s38 offen nt lds
  s_add_u32 m0, s35, 28672
  s_add_u32 s38, s36, 135168
  buffer_load_dwordx4 v157, s[20:23], s38 offen nt lds
concat_heads__gqa_block_cached__gqa_block_cached__near_ridge_kernel_lo4_15:
  s_cmp_eq_u32 s30, 4
  s_cbranch_scc0 concat_heads__gqa_block_cached__gqa_block_cached__near_ridge_kernel_c4_16
  s_lshl_b32 s35, s45, 3
  s_add_u32 s35, s35, s46
  s_lshl_b32 s35, s35, 2
  v_mov_b32 v154, s35
  buffer_load_dword v166, v154, s[96:99], 0 offen sc1
concat_heads__gqa_block_cached__gqa_block_cached__near_ridge_kernel_c4_16:
  s_mov_b32 s39, 1
  s_add_u32 s41, s58, 32768
  s_and_b32 s41, s41, 0x1ffff
  s_mov_b32 s34, 131072
  s_mov_b32 s33, 0
  s_mov_b32 s47, 32768
  s_cmp_lt_u32 s28, 4
  s_cbranch_scc0 concat_heads__gqa_block_cached__gqa_block_cached__near_ridge_kernel_aloop1
concat_heads__gqa_block_cached__gqa_block_cached__near_ridge_kernel_aloop0:
  s_cmp_le_u32 s39, 12
  s_cbranch_scc0 concat_heads__gqa_block_cached__gqa_block_cached__near_ridge_kernel_atailw
  s_waitcnt vmcnt(16)
concat_heads__gqa_block_cached__gqa_block_cached__near_ridge_kernel_atailb:
  s_add_u32 s33, s33, 32768
  s_cmp_eq_u32 s33, 163840
  s_cselect_b32 s33, 0, s33
  s_add_u32 s47, s47, 32768
  s_cmp_eq_u32 s47, 163840
  s_cselect_b32 s47, 0, s47
  s_add_u32 s34, s34, 32768
  s_cmp_eq_u32 s34, 163840
  s_cselect_b32 s34, 0, s34
  s_barrier
  s_setprio 1
  s_waitcnt lgkmcnt(3)
  v_mfma_f32_32x32x16_bf16 v[96:111], v[128:131], v[64:67], v[112:127]
  ds_read_b128 v[128:131], v144 offset:4096
  s_waitcnt lgkmcnt(3)
  v_mfma_f32_32x32x16_bf16 v[96:111], v[132:135], v[68:71], v[96:111]
  ds_read_b128 v[132:135], v145 offset:4096
  s_waitcnt lgkmcnt(3)
  v_mfma_f32_32x32x16_bf16 v[96:111], v[136:139], v[72:75], v[96:111]
  ds_read_b128 v[136:139], v146 offset:4096
  s_waitcnt lgkmcnt(3)
  v_mfma_f32_32x32x16_bf16 v[96:111], v[140:143], v[76:79], v[96:111]
  ds_read_b128 v[140:143], v147 offset:4096
  v_add_u32 v144, s33, v149
  v_xor_b32 v145, 64, v144
  v_xor_b32 v146, 128, v144
  v_xor_b32 v147, 192, v144
  s_waitcnt lgkmcnt(3)
  v_mfma_f32_32x32x16_bf16 v[96:111], v[128:131], v[80:83], v[96:111]
  ds_read_b64_tr_b16 v[128:129], v144 offset:0
  ds_read_b64_tr_b16 v[130:131], v144 offset:1024
  s_waitcnt lgkmcnt(4)
  v_mfma_f32_32x32x16_bf16 v[96:111], v[132:135], v[84:87], v[96:111]
  ds_read_b64_tr_b16 v[132:133], v145 offset:0
  ds_read_b64_tr_b16 v[134:135], v145 offset:1024
  s_waitcnt lgkmcnt(5)
  v_mfma_f32_32x32x16_bf16 v[96:111], v[136:139], v[88:91], v[96:111]
  ds_read_b64_tr_b16 v[136:137], v146 offset:0
  ds_read_b64_tr_b16 v[138:139], v146 offset:1024
  s_waitcnt lgkmcnt(6)
  v_mfma_f32_32x32x16_bf16 v[96:111], v[140:143], v[92:95], v[96:111]
  ds_read_b64_tr_b16 v[140:141], v147 offset:0
  ds_read_b64_tr_b16 v[142:143], v147 offset:1024
  s_setprio 0
  s_nop 9
  v_max3_f32 v152, v96, v97, v98
  v_max3_f32 v153, v99, v100, v101
  v_max3_f32 v152, v152, v102, v103
  v_max3_f32 v153, v153, v104, v105
  v_max3_f32 v152, v152, v106, v107
  v_max3_f32 v153, v153, v108, v109
  v_max3_f32 v152, v152, v110, v111
  v_max_f32 v152, v152, v153
  v_cmp_lt_f32 vcc, 0x41200000, v152
  s_cbranch_vccnz concat_heads__gqa_block_cached__gqa_block_cached__near_ridge_kernel_rare_lp0
concat_heads__gqa_block_cached__gqa_block_cached__near_ridge_kernel_back_lp0:
  v_exp_f32 v96, v96
  v_exp_f32 v97, v97
  v_add_f32 v150, v150, v96
  v_exp_f32 v98, v98
  v_add_f32 v151, v151, v97
  v_exp_f32 v99, v99
  v_add_f32 v150, v150, v98
  v_exp_f32 v100, v100
  v_add_f32 v151, v151, v99
  v_exp_f32 v101, v101
  v_add_f32 v150, v150, v100
  v_exp_f32 v102, v102
  v_add_f32 v151, v151, v101
  v_exp_f32 v103, v103
  v_add_f32 v150, v150, v102
  v_cvt_pk_bf16_f32 v96, v96, v97
  v_add_f32 v151, v151, v103
  v_cvt_pk_bf16_f32 v97, v98, v99
  v_cvt_pk_bf16_f32 v98, v100, v101
  v_cvt_pk_bf16_f32 v99, v102, v103
  s_setprio 1
  s_nop 1
  s_waitcnt lgkmcnt(6)
  v_mfma_f32_32x32x16_bf16 v[0:15], v[128:131], v[96:99], v[0:15]
  ds_read_b64_tr_b16 v[128:129], v144 offset:4096
  ds_read_b64_tr_b16 v[130:131], v144 offset:5120
  v_exp_f32 v104, v104
  v_exp_f32 v105, v105
  v_add_f32 v150, v150, v104
  s_waitcnt lgkmcnt(6)
  v_mfma_f32_32x32x16_bf16 v[16:31], v[132:135], v[96:99], v[16:31]
  ds_read_b64_tr_b16 v[132:133], v145 offset:4096
  ds_read_b64_tr_b16 v[134:135], v145 offset:5120
  v_add_f32 v151, v151, v105
  v_exp_f32 v106, v106
  v_exp_f32 v107, v107
  v_add_f32 v150, v150, v106
  v_cvt_pk_bf16_f32 v100, v104, v105
  s_waitcnt lgkmcnt(6)
  v_mfma_f32_32x32x16_bf16 v[32:47], v[136:139], v[96:99], v[32:47]
  ds_read_b64_tr_b16 v[136:137], v146 offset:4096
  ds_read_b64_tr_b16 v[138:139], v146 offset:5120
  v_add_f32 v151, v151, v107
  v_exp_f32 v108, v108
  v_exp_f32 v109, v109
  v_add_f32 v150, v150, v108
  v_cvt_pk_bf16_f32 v101, v106, v107
  s_waitcnt lgkmcnt(6)
  v_mfma_f32_32x32x16_bf16 v[48:63], v[140:143], v[96:99], v[48:63]
  ds_read_b64_tr_b16 v[140:141], v147 offset:4096
  ds_read_b64_tr_b16 v[142:143], v147 offset:5120
  v_add_f32 v151, v151, v109
  v_exp_f32 v110, v110
  v_exp_f32 v111, v111
  v_add_f32 v150, v150, v110
  v_cvt_pk_bf16_f32 v102, v108, v109
  v_add_f32 v151, v151, v111
  v_cvt_pk_bf16_f32 v103, v110, v111
  v_add_u32 v144, s47, v148
  v_xor_b32 v145, 32, v144
  v_xor_b32 v146, 64, v144
  v_xor_b32 v147, 96, v144
  s_waitcnt lgkmcnt(6)
  v_mfma_f32_32x32x16_bf16 v[0:15], v[128:131], v[100:103], v[0:15]
  ds_read_b128 v[128:131], v144 offset:0
  s_waitcnt lgkmcnt(5)
  v_mfma_f32_32x32x16_bf16 v[16:31], v[132:135], v[100:103], v[16:31]
  ds_read_b128 v[132:135], v145 offset:0
  s_waitcnt lgkmcnt(4)
  v_mfma_f32_32x32x16_bf16 v[32:47], v[136:139], v[100:103], v[32:47]
  ds_read_b128 v[136:139], v146 offset:0
  s_waitcnt lgkmcnt(3)
  v_mfma_f32_32x32x16_bf16 v[48:63], v[140:143], v[100:103], v[48:63]
  ds_read_b128 v[140:143], v147 offset:0
  s_add_u32 s41, s41, 8192
  s_and_b32 s41, s41, 0x1ffff
  s_cmp_le_u32 s39, 11
  s_cbranch_scc0 concat_heads__gqa_block_cached__gqa_block_cached__near_ridge_kernel_anofill
  s_add_u32 s35, s34, s32
  s_add_u32 s36, s41, s32
  s_add_u32 s37, s41, 0
  s_add_u32 m0, s35, 0
  s_add_u32 s38, s37, 0
  buffer_load_dwordx4 v156, s[16:19], s38 offen nt lds
  s_add_u32 m0, s35, 4096
  s_add_u32 s38, s37, 128
  buffer_load_dwordx4 v156, s[16:19], s38 offen nt lds
  s_add_u32 m0, s35, 8192
  s_add_u32 s38, s37, 131072
  buffer_load_dwordx4 v156, s[16:19], s38 offen nt lds
  s_add_u32 m0, s35, 12288
  s_add_u32 s38, s37, 131200
  buffer_load_dwordx4 v156, s[16:19], s38 offen nt lds
  s_add_u32 m0, s35, 16384
  s_add_u32 s38, s36, 0
  buffer_load_dwordx4 v157, s[20:23], s38 offen nt lds
  s_add_u32 m0, s35, 20480
  s_add_u32 s38, s36, 4096
  buffer_load_dwordx4 v157, s[20:23], s38 offen nt lds
  s_add_u32 m0, s35, 24576
  s_add_u32 s38, s36, 131072
  buffer_load_dwordx4 v157, s[20:23], s38 offen nt lds
  s_add_u32 m0, s35, 28672
  s_add_u32 s38, s36, 135168
  buffer_load_dwordx4 v157, s[20:23], s38 offen nt lds
  s_branch concat_heads__gqa_block_cached__gqa_block_cached__near_ridge_kernel_afilled
concat_heads__gqa_block_cached__gqa_block_cached__near_ridge_kernel_anofill:
  s_cmp_eq_u32 s39, 14
  s_cbranch_scc1 concat_heads__gqa_block_cached__gqa_block_cached__near_ridge_kernel_afilled
  s_branch concat_heads__gqa_block_cached__gqa_block_cached__near_ridge_kernel_awo
concat_heads__gqa_block_cached__gqa_block_cached__near_ridge_kernel_afilled:
  s_add_u32 s39, s39, 1
  s_cmp_lt_u32 s39, 15
  s_cbranch_scc1 concat_heads__gqa_block_cached__gqa_block_cached__near_ridge_kernel_aloop0
  s_branch concat_heads__gqa_block_cached__gqa_block_cached__near_ridge_kernel_alast
concat_heads__gqa_block_cached__gqa_block_cached__near_ridge_kernel_aloop1:
  s_barrier
  s_add_u32 s33, s33, 32768
  s_cmp_eq_u32 s33, 163840
  s_cselect_b32 s33, 0, s33
  s_add_u32 s47, s47, 32768
  s_cmp_eq_u32 s47, 163840
  s_cselect_b32 s47, 0, s47
  s_setprio 1
  s_waitcnt lgkmcnt(3)
  v_mfma_f32_32x32x16_bf16 v[96:111], v[128:131], v[64:67], v[112:127]
  ds_read_b128 v[128:131], v144 offset:4096
  s_waitcnt lgkmcnt(3)
  v_mfma_f32_32x32x16_bf16 v[96:111], v[132:135], v[68:71], v[96:111]
  ds_read_b128 v[132:135], v145 offset:4096
  s_waitcnt lgkmcnt(3)
  v_mfma_f32_32x32x16_bf16 v[96:111], v[136:139], v[72:75], v[96:111]
  ds_read_b128 v[136:139], v146 offset:4096
  s_waitcnt lgkmcnt(3)
  v_mfma_f32_32x32x16_bf16 v[96:111], v[140:143], v[76:79], v[96:111]
  ds_read_b128 v[140:143], v147 offset:4096
  v_add_u32 v144, s33, v149
  v_xor_b32 v145, 64, v144
  v_xor_b32 v146, 128, v144
  v_xor_b32 v147, 192, v144
  s_waitcnt lgkmcnt(3)
  v_mfma_f32_32x32x16_bf16 v[96:111], v[128:131], v[80:83], v[96:111]
  ds_read_b64_tr_b16 v[128:129], v144 offset:0
  ds_read_b64_tr_b16 v[130:131], v144 offset:1024
  s_waitcnt lgkmcnt(4)
  v_mfma_f32_32x32x16_bf16 v[96:111], v[132:135], v[84:87], v[96:111]
  ds_read_b64_tr_b16 v[132:133], v145 offset:0
  ds_read_b64_tr_b16 v[134:135], v145 offset:1024
  s_waitcnt lgkmcnt(5)
  v_mfma_f32_32x32x16_bf16 v[96:111], v[136:139], v[88:91], v[96:111]
  ds_read_b64_tr_b16 v[136:137], v146 offset:0
  ds_read_b64_tr_b16 v[138:139], v146 offset:1024
  s_waitcnt lgkmcnt(6)
  v_mfma_f32_32x32x16_bf16 v[96:111], v[140:143], v[92:95], v[96:111]
  ds_read_b64_tr_b16 v[140:141], v147 offset:0
  ds_read_b64_tr_b16 v[142:143], v147 offset:1024
  s_setprio 0
  s_nop 9
  v_max3_f32 v152, v96, v97, v98
  v_max3_f32 v153, v99, v100, v101
  v_max3_f32 v152, v152, v102, v103
  v_max3_f32 v153, v153, v104, v105
  v_max3_f32 v152, v152, v106, v107
  v_max3_f32 v153, v153, v108, v109
  v_max3_f32 v152, v152, v110, v111
  v_max_f32 v152, v152, v153
  v_cmp_lt_f32 vcc, 0x41200000, v152
  s_cbranch_vccnz concat_heads__gqa_block_cached__gqa_block_cached__near_ridge_kernel_rare_lp1
concat_heads__gqa_block_cached__gqa_block_cached__near_ridge_kernel_back_lp1:
  v_exp_f32 v96, v96
  v_exp_f32 v97, v97
  v_add_f32 v150, v150, v96
  v_exp_f32 v98, v98
  v_add_f32 v151, v151, v97
  v_exp_f32 v99, v99
  v_add_f32 v150, v150, v98
  v_exp_f32 v100, v100
  v_add_f32 v151, v151, v99
  v_exp_f32 v101, v101
  v_add_f32 v150, v150, v100
  v_exp_f32 v102, v102
  v_add_f32 v151, v151, v101
  v_exp_f32 v103, v103
  v_add_f32 v150, v150, v102
  v_cvt_pk_bf16_f32 v96, v96, v97
  v_add_f32 v151, v151, v103
  v_cvt_pk_bf16_f32 v97, v98, v99
  v_cvt_pk_bf16_f32 v98, v100, v101
  v_cvt_pk_bf16_f32 v99, v102, v103
  s_setprio 1
  s_nop 1
  s_waitcnt lgkmcnt(6)
  v_mfma_f32_32x32x16_bf16 v[0:15], v[128:131], v[96:99], v[0:15]
  ds_read_b64_tr_b16 v[128:129], v144 offset:4096
  ds_read_b64_tr_b16 v[130:131], v144 offset:5120
  v_exp_f32 v104, v104
  v_exp_f32 v105, v105
  v_add_f32 v150, v150, v104
  s_waitcnt lgkmcnt(6)
  v_mfma_f32_32x32x16_bf16 v[16:31], v[132:135], v[96:99], v[16:31]
  ds_read_b64_tr_b16 v[132:133], v145 offset:4096
  ds_read_b64_tr_b16 v[134:135], v145 offset:5120
  v_add_f32 v151, v151, v105
  v_exp_f32 v106, v106
  v_exp_f32 v107, v107
  v_add_f32 v150, v150, v106
  v_cvt_pk_bf16_f32 v100, v104, v105
  s_waitcnt lgkmcnt(6)
  v_mfma_f32_32x32x16_bf16 v[32:47], v[136:139], v[96:99], v[32:47]
  ds_read_b64_tr_b16 v[136:137], v146 offset:4096
  ds_read_b64_tr_b16 v[138:139], v146 offset:5120
  v_add_f32 v151, v151, v107
  v_exp_f32 v108, v108
  v_exp_f32 v109, v109
  v_add_f32 v150, v150, v108
  v_cvt_pk_bf16_f32 v101, v106, v107
  s_waitcnt lgkmcnt(6)
  v_mfma_f32_32x32x16_bf16 v[48:63], v[140:143], v[96:99], v[48:63]
  ds_read_b64_tr_b16 v[140:141], v147 offset:4096
  ds_read_b64_tr_b16 v[142:143], v147 offset:5120
  v_add_f32 v151, v151, v109
  v_exp_f32 v110, v110
  v_exp_f32 v111, v111
  v_add_f32 v150, v150, v110
  v_cvt_pk_bf16_f32 v102, v108, v109
  v_add_f32 v151, v151, v111
  v_cvt_pk_bf16_f32 v103, v110, v111
  v_add_u32 v144, s47, v148
  v_xor_b32 v145, 32, v144
  v_xor_b32 v146, 64, v144
  v_xor_b32 v147, 96, v144
  s_waitcnt lgkmcnt(6)
  v_mfma_f32_32x32x16_bf16 v[0:15], v[128:131], v[100:103], v[0:15]
  ds_read_b128 v[128:131], v144 offset:0
  s_waitcnt lgkmcnt(5)
  v_mfma_f32_32x32x16_bf16 v[16:31], v[132:135], v[100:103], v[16:31]
  ds_read_b128 v[132:135], v145 offset:0
  s_waitcnt lgkmcnt(4)
  v_mfma_f32_32x32x16_bf16 v[32:47], v[136:139], v[100:103], v[32:47]
  ds_read_b128 v[136:139], v146 offset:0
  s_waitcnt lgkmcnt(3)
  v_mfma_f32_32x32x16_bf16 v[48:63], v[140:143], v[100:103], v[48:63]
  ds_read_b128 v[140:143], v147 offset:0
  s_cmp_eq_u32 s39, 13
  s_cbranch_scc1 concat_heads__gqa_block_cached__gqa_block_cached__near_ridge_kernel_wtl
concat_heads__gqa_block_cached__gqa_block_cached__near_ridge_kernel_wtb:
  s_add_u32 s39, s39, 1
  s_cmp_lt_u32 s39, 15
  s_cbranch_scc1 concat_heads__gqa_block_cached__gqa_block_cached__near_ridge_kernel_aloop1
concat_heads__gqa_block_cached__gqa_block_cached__near_ridge_kernel_alast:
  s_barrier
  s_setprio 1
  s_waitcnt lgkmcnt(3)
  v_mfma_f32_32x32x16_bf16 v[96:111], v[128:131], v[64:67], v[112:127]
  ds_read_b128 v[128:131], v144 offset:4096
  s_waitcnt lgkmcnt(3)
  v_mfma_f32_32x32x16_bf16 v[96:111], v[132:135], v[68:71], v[96:111]
  ds_read_b128 v[132:135], v145 offset:4096
  s_waitcnt lgkmcnt(3)
  v_mfma_f32_32x32x16_bf16 v[96:111], v[136:139], v[72:75], v[96:111]
  ds_read_b128 v[136:139], v146 offset:4096
  s_waitcnt lgkmcnt(3)
  v_mfma_f32_32x32x16_bf16 v[96:111], v[140:143], v[76:79], v[96:111]
  ds_read_b128 v[140:143], v147 offset:4096
  v_add_u32 v144, 0, v149
  v_xor_b32 v145, 64, v144
  v_xor_b32 v146, 128, v144
  v_xor_b32 v147, 192, v144
  s_waitcnt lgkmcnt(3)
  v_mfma_f32_32x32x16_bf16 v[96:111], v[128:131], v[80:83], v[96:111]
  ds_read_b64_tr_b16 v[128:129], v144 offset:0
  ds_read_b64_tr_b16 v[130:131], v144 offset:1024
  s_waitcnt lgkmcnt(4)
  v_mfma_f32_32x32x16_bf16 v[96:111], v[132:135], v[84:87], v[96:111]
  ds_read_b64_tr_b16 v[132:133], v145 offset:0
  ds_read_b64_tr_b16 v[134:135], v145 offset:1024
  s_waitcnt lgkmcnt(5)
  v_mfma_f32_32x32x16_bf16 v[96:111], v[136:139], v[88:91], v[96:111]
  ds_read_b64_tr_b16 v[136:137], v146 offset:0
  ds_read_b64_tr_b16 v[138:139], v146 offset:1024
  s_waitcnt lgkmcnt(6)
  v_mfma_f32_32x32x16_bf16 v[96:111], v[140:143], v[92:95], v[96:111]
  ds_read_b64_tr_b16 v[140:141], v147 offset:0
  ds_read_b64_tr_b16 v[142:143], v147 offset:1024
  s_setprio 0
  s_nop 9
  v_max3_f32 v152, v96, v97, v98
  v_max3_f32 v153, v99, v100, v101
  v_max3_f32 v152, v152, v102, v103
  v_max3_f32 v153, v153, v104, v105
  v_max3_f32 v152, v152, v106, v107
  v_max3_f32 v153, v153, v108, v109
  v_max3_f32 v152, v152, v110, v111
  v_max_f32 v152, v152, v153
  v_cmp_lt_f32 vcc, 0x41200000, v152
  s_cbranch_vccnz concat_heads__gqa_block_cached__gqa_block_cached__near_ridge_kernel_rare_t15
concat_heads__gqa_block_cached__gqa_block_cached__near_ridge_kernel_back_t15:
  v_exp_f32 v96, v96
  v_exp_f32 v97, v97
  v_add_f32 v150, v150, v96
  v_exp_f32 v98, v98
  v_add_f32 v151, v151, v97
  v_exp_f32 v99, v99
  v_add_f32 v150, v150, v98
  v_exp_f32 v100, v100
  v_add_f32 v151, v151, v99
  v_exp_f32 v101, v101
  v_add_f32 v150, v150, v100
  v_exp_f32 v102, v102
  v_add_f32 v151, v151, v101
  v_exp_f32 v103, v103
  v_add_f32 v150, v150, v102
  v_cvt_pk_bf16_f32 v96, v96, v97
  v_add_f32 v151, v151, v103
  v_cvt_pk_bf16_f32 v97, v98, v99
  v_cvt_pk_bf16_f32 v98, v100, v101
  v_cvt_pk_bf16_f32 v99, v102, v103
  s_setprio 1
  s_nop 1
  s_waitcnt lgkmcnt(6)
  v_mfma_f32_32x32x16_bf16 v[0:15], v[128:131], v[96:99], v[0:15]
  ds_read_b64_tr_b16 v[128:129], v144 offset:4096
  ds_read_b64_tr_b16 v[130:131], v144 offset:5120
  v_exp_f32 v104, v104
  v_exp_f32 v105, v105
  v_add_f32 v150, v150, v104
  s_waitcnt lgkmcnt(6)
  v_mfma_f32_32x32x16_bf16 v[16:31], v[132:135], v[96:99], v[16:31]
  ds_read_b64_tr_b16 v[132:133], v145 offset:4096
  ds_read_b64_tr_b16 v[134:135], v145 offset:5120
  v_add_f32 v151, v151, v105
  v_exp_f32 v106, v106
  v_exp_f32 v107, v107
  v_add_f32 v150, v150, v106
  v_cvt_pk_bf16_f32 v100, v104, v105
  s_waitcnt lgkmcnt(6)
  v_mfma_f32_32x32x16_bf16 v[32:47], v[136:139], v[96:99], v[32:47]
  ds_read_b64_tr_b16 v[136:137], v146 offset:4096
  ds_read_b64_tr_b16 v[138:139], v146 offset:5120
  v_add_f32 v151, v151, v107
  v_exp_f32 v108, v108
  v_exp_f32 v109, v109
  v_add_f32 v150, v150, v108
  v_cvt_pk_bf16_f32 v101, v106, v107
  s_waitcnt lgkmcnt(6)
  v_mfma_f32_32x32x16_bf16 v[48:63], v[140:143], v[96:99], v[48:63]
  ds_read_b64_tr_b16 v[140:141], v147 offset:4096
  ds_read_b64_tr_b16 v[142:143], v147 offset:5120
  v_add_f32 v151, v151, v109
  v_exp_f32 v110, v110
  v_exp_f32 v111, v111
  v_add_f32 v150, v150, v110
  v_cvt_pk_bf16_f32 v102, v108, v109
  v_add_f32 v151, v151, v111
  v_cvt_pk_bf16_f32 v103, v110, v111
  s_nop 1
  s_waitcnt lgkmcnt(6)
  v_mfma_f32_32x32x16_bf16 v[0:15], v[128:131], v[100:103], v[0:15]
  s_waitcnt lgkmcnt(4)
  v_mfma_f32_32x32x16_bf16 v[16:31], v[132:135], v[100:103], v[16:31]
  s_waitcnt lgkmcnt(2)
  v_mfma_f32_32x32x16_bf16 v[32:47], v[136:139], v[100:103], v[32:47]
  s_waitcnt lgkmcnt(0)
  v_mfma_f32_32x32x16_bf16 v[48:63], v[140:143], v[100:103], v[48:63]
  v_add_f32 v150, v150, v151
  s_nop 0
  v_mov_b32 v151, v150
  s_nop 1
  v_permlane32_swap_b32 v150, v151
  s_nop 0
  v_add_f32 v150, v150, v151
  s_nop 0
  v_rcp_f32 v150, v150
  s_nop 11
  s_lshl_b32 s35, s30, 18
  s_add_u32 s36, s44, s29
  s_lshl_b32 s36, s36, 13
  s_add_u32 s35, s35, s36
  s_mul_i32 s37, s29, 10240
  s_lshl_b32 s38, s30, 11
  s_add_u32 s37, s37, s38
  s_add_u32 s37, s37, 81920
  v_add_u32 v154, s37, v161
  v_mul_f32 v0, v0, v150
  v_mul_f32 v1, v1, v150
  v_mul_f32 v2, v2, v150
  v_mul_f32 v3, v3, v150
  v_mul_f32 v4, v4, v150
  v_mul_f32 v5, v5, v150
  v_mul_f32 v6, v6, v150
  v_mul_f32 v7, v7, v150
  v_mul_f32 v8, v8, v150
  v_mul_f32 v9, v9, v150
  v_mul_f32 v10, v10, v150
  v_mul_f32 v11, v11, v150
  v_mul_f32 v12, v12, v150
  v_mul_f32 v13, v13, v150
  v_mul_f32 v14, v14, v150
  v_mul_f32 v15, v15, v150
  v_cvt_pk_bf16_f32 v64, v0, v1
  v_cvt_pk_bf16_f32 v65, v2, v3
  v_cvt_pk_bf16_f32 v66, v4, v5
  v_cvt_pk_bf16_f32 v67, v6, v7
  s_add_u32 s36, s35, 0
  buffer_store_dwordx4 v[64:67], v161, s[24:27], s36 offen sc1
  v_mul_f32 v16, v16, v150
  v_mul_f32 v17, v17, v150
  v_mul_f32 v18, v18, v150
  v_mul_f32 v19, v19, v150
  v_mul_f32 v20, v20, v150
  v_mul_f32 v21, v21, v150
  v_mul_f32 v22, v22, v150
  v_mul_f32 v23, v23, v150
  v_cvt_pk_bf16_f32 v68, v8, v9
  v_cvt_pk_bf16_f32 v69, v10, v11
  v_cvt_pk_bf16_f32 v70, v12, v13
  v_cvt_pk_bf16_f32 v71, v14, v15
  s_add_u32 s36, s35, 1024
  buffer_store_dwordx4 v[68:71], v161, s[24:27], s36 offen sc1
  v_mul_f32 v24, v24, v150
  v_mul_f32 v25, v25, v150
  v_mul_f32 v26, v26, v150
  v_mul_f32 v27, v27, v150
  v_mul_f32 v28, v28, v150
  v_mul_f32 v29, v29, v150
  v_mul_f32 v30, v30, v150
  v_mul_f32 v31, v31, v150
  v_cvt_pk_bf16_f32 v72, v16, v17
  v_cvt_pk_bf16_f32 v73, v18, v19
  v_cvt_pk_bf16_f32 v74, v20, v21
  v_cvt_pk_bf16_f32 v75, v22, v23
  s_add_u32 s36, s35, 2048
  buffer_store_dwordx4 v[72:75], v161, s[24:27], s36 offen sc1
  v_mul_f32 v32, v32, v150
  v_mul_f32 v33, v33, v150
  v_mul_f32 v34, v34, v150
  v_mul_f32 v35, v35, v150
  v_mul_f32 v36, v36, v150
  v_mul_f32 v37, v37, v150
  v_mul_f32 v38, v38, v150
  v_mul_f32 v39, v39, v150
  v_cvt_pk_bf16_f32 v76, v24, v25
  v_cvt_pk_bf16_f32 v77, v26, v27
  v_cvt_pk_bf16_f32 v78, v28, v29
  v_cvt_pk_bf16_f32 v79, v30, v31
  s_add_u32 s36, s35, 3072
  buffer_store_dwordx4 v[76:79], v161, s[24:27], s36 offen sc1
  v_mul_f32 v40, v40, v150
  v_mul_f32 v41, v41, v150
  v_mul_f32 v42, v42, v150
  v_mul_f32 v43, v43, v150
  v_mul_f32 v44, v44, v150
  v_mul_f32 v45, v45, v150
  v_mul_f32 v46, v46, v150
  v_mul_f32 v47, v47, v150
  v_cvt_pk_bf16_f32 v80, v32, v33
  v_cvt_pk_bf16_f32 v81, v34, v35
  v_cvt_pk_bf16_f32 v82, v36, v37
  v_cvt_pk_bf16_f32 v83, v38, v39
  s_add_u32 s36, s35, 4096
  buffer_store_dwordx4 v[80:83], v161, s[24:27], s36 offen sc1
  v_mul_f32 v48, v48, v150
  v_mul_f32 v49, v49, v150
  v_mul_f32 v50, v50, v150
  v_mul_f32 v51, v51, v150
  v_mul_f32 v52, v52, v150
  v_mul_f32 v53, v53, v150
  v_mul_f32 v54, v54, v150
  v_mul_f32 v55, v55, v150
  v_cvt_pk_bf16_f32 v84, v40, v41
  v_cvt_pk_bf16_f32 v85, v42, v43
  v_cvt_pk_bf16_f32 v86, v44, v45
  v_cvt_pk_bf16_f32 v87, v46, v47
  s_add_u32 s36, s35, 5120
  buffer_store_dwordx4 v[84:87], v161, s[24:27], s36 offen sc1
  v_mul_f32 v56, v56, v150
  v_mul_f32 v57, v57, v150
  v_mul_f32 v58, v58, v150
  v_mul_f32 v59, v59, v150
  v_mul_f32 v60, v60, v150
  v_mul_f32 v61, v61, v150
  v_mul_f32 v62, v62, v150
  v_mul_f32 v63, v63, v150
  v_cvt_pk_bf16_f32 v88, v48, v49
  v_cvt_pk_bf16_f32 v89, v50, v51
  v_cvt_pk_bf16_f32 v90, v52, v53
  v_cvt_pk_bf16_f32 v91, v54, v55
  s_add_u32 s36, s35, 6144
  buffer_store_dwordx4 v[88:91], v161, s[24:27], s36 offen sc1
  v_cvt_pk_bf16_f32 v92, v56, v57
  v_cvt_pk_bf16_f32 v93, v58, v59
  v_cvt_pk_bf16_f32 v94, v60, v61
  v_cvt_pk_bf16_f32 v95, v62, v63
  s_add_u32 s36, s35, 7168
  buffer_store_dwordx4 v[92:95], v161, s[24:27], s36 offen sc1
  ds_write_b128 v154, v[64:67] offset:0
  ds_write_b128 v154, v[68:71] offset:1024
  ds_write_b128 v154, v[72:75] offset:20480
  ds_write_b128 v154, v[76:79] offset:21504
  ds_write_b128 v154, v[80:83] offset:40960
  ds_write_b128 v154, v[84:87] offset:41984
  ds_write_b128 v154, v[88:91] offset:61440
  ds_write_b128 v154, v[92:95] offset:62464
  s_mov_b32 s35, 34603008
  s_add_u32 s20, s56, s35
  s_addc_u32 s21, s57, 0
  s_mov_b32 s22, 65536
  s_mov_b32 s23, 0x00020000
  s_lshl_b32 s35, s45, 3
  s_add_u32 s35, s35, s46
  s_lshl_b32 s35, s35, 2
  s_add_u32 s35, s35, s100
  s_mul_i32 s35, s35, 40960
  s_add_u32 s35, s35, 23068672
  s_add_u32 s12, s56, s35
  s_addc_u32 s13, s57, 0
  s_mov_b32 s14, 7905280
  s_mov_b32 s15, 0x00020000
  s_mov_b32 s16, s6
  s_mov_b32 s17, s7
  s_mov_b32 s18, 2621440
  s_mov_b32 s19, 0x00020000
  s_cmp_ge_u32 s28, 8
  s_cbranch_scc1 concat_heads__gqa_block_cached__gqa_block_cached__near_ridge_kernel_oload
  s_and_b32 s47, s28, 3
  s_lshr_b32 s41, s28, 2
  s_lshl_b32 s35, s29, 13
  s_add_u32 s35, s35, 16384
  v_subrev_u32 v130, s35, v149
  s_lshl_b32 s35, s47, 6
  v_xor_b32 v130, s35, v130
  s_lshl_b32 s35, s100, 1
  s_sub_u32 s61, s44, s35
  s_add_u32 s61, s61, s41
  s_lshl_b32 s42, s41, 13
  s_lshl_b32 s35, s47, 11
  s_add_u32 s42, s42, s35
  s_lshl_b32 s43, s47, 13
  s_waitcnt vmcnt(8) lgkmcnt(0)
  s_barrier
  s_mov_b32 s33, 32768
  s_mov_b32 s34, 81920
  s_mov_b32 s59, 3
  s_mov_b32 s4, 0
  s_cmp_eq_u32 s41, 0
  s_cbranch_scc0 concat_heads__gqa_block_cached__gqa_block_cached__near_ridge_kernel_og1
concat_heads__gqa_block_cached__gqa_block_cached__near_ridge_kernel_og0:
  v_add_u32 v128, s33, v130
  v_add_u32 v129, s34, v161
  ds_read_b64_tr_b16 v[32:33], v128 offset:0
  ds_read_b64_tr_b16 v[34:35], v128 offset:1024
  ds_read_b128 v[36:39], v129 offset:6144
  ds_read_b128 v[40:43], v129 offset:8192
  ds_read_b64_tr_b16 v[44:45], v128 offset:4096
  ds_read_b64_tr_b16 v[46:47], v128 offset:5120
  ds_read_b128 v[48:51], v129 offset:7168
  ds_read_b128 v[52:55], v129 offset:9216
  s_waitcnt lgkmcnt(5)
  v_mfma_f32_32x32x16_bf16 v[0:15], v[32:35], v[36:39], 0
  ds_read_b64_tr_b16 v[56:57], v128 offset:8192
  ds_read_b64_tr_b16 v[58:59], v128 offset:9216
  ds_read_b128 v[60:63], v129 offset:16384
  ds_read_b128 v[64:67], v129 offset:18432
  s_waitcnt lgkmcnt(8)
  v_mfma_f32_32x32x16_bf16 v[16:31], v[32:35], v[40:43], 0
  ds_read_b64_tr_b16 v[68:69], v128 offset:12288
  ds_read_b64_tr_b16 v[70:71], v128 offset:13312
  ds_read_b128 v[72:75], v129 offset:17408
  ds_read_b128 v[76:79], v129 offset:19456
  s_waitcnt lgkmcnt(9)
  v_mfma_f32_32x32x16_bf16 v[0:15], v[44:47], v[48:51], v[0:15]
  s_waitcnt lgkmcnt(8)
  v_mfma_f32_32x32x16_bf16 v[16:31], v[44:47], v[52:55], v[16:31]
  s_add_u32 s34, s34, 20480
  s_cmp_eq_u32 s34, 163840
  s_cselect_b32 s34, 81920, s34
  s_cmp_eq_u32 s33, 0
  s_cselect_b32 s35, 16384, s33
  s_add_u32 s35, s35, 16384
  s_cmp_eq_u32 s35, 81920
  s_cselect_b32 s33, 0, s35
  v_add_u32 v128, s33, v130
  v_add_u32 v129, s34, v161
  s_waitcnt lgkmcnt(0)
  s_lshr_b32 s35, s59, 2
  s_add_u32 s35, s35, s100
  s_and_b32 s35, s35, 3
  s_lshl_b32 s35, s35, 1
  s_add_u32 s35, s35, s61
  s_lshl_b32 s35, s35, 17
  s_and_b32 s36, s59, 3
  s_lshl_b32 s36, s36, 15
  s_add_u32 s35, s35, s36
  s_add_u32 s35, s35, s43
  s_add_u32 s36, s4, s42
  s_add_u32 m0, s36, 0
  s_add_u32 s38, s35, 0
  buffer_load_dwordx4 v159, s[8:11], s38 offen nt lds
  s_add_u32 m0, s36, 1024
  s_add_u32 s38, s35, 4096
  buffer_load_dwordx4 v159, s[8:11], s38 offen nt lds
  s_add_u32 s59, s59, 1
  s_cmp_eq_u32 s4, 0
  s_cselect_b32 s35, 16384, s4
  s_add_u32 s35, s35, 16384
  s_cmp_eq_u32 s35, 81920
  s_cselect_b32 s4, 0, s35
  s_mov_b32 s39, 1
  s_waitcnt vmcnt(2)
  s_branch concat_heads__gqa_block_cached__gqa_block_cached__near_ridge_kernel_obar0
concat_heads__gqa_block_cached__gqa_block_cached__near_ridge_kernel_oloop0:
concat_heads__gqa_block_cached__gqa_block_cached__near_ridge_kernel_obar0:
  s_barrier
  v_mfma_f32_32x32x16_bf16 v[0:15], v[56:59], v[60:63], v[0:15]
  ds_read_b64_tr_b16 v[32:33], v128 offset:0
  ds_read_b64_tr_b16 v[34:35], v128 offset:1024
  ds_read_b128 v[36:39], v129 offset:6144
  ds_read_b128 v[40:43], v129 offset:8192
  v_mfma_f32_32x32x16_bf16 v[16:31], v[56:59], v[64:67], v[16:31]
  ds_read_b64_tr_b16 v[44:45], v128 offset:4096
  ds_read_b64_tr_b16 v[46:47], v128 offset:5120
  ds_read_b128 v[48:51], v129 offset:7168
  ds_read_b128 v[52:55], v129 offset:9216
  v_mfma_f32_32x32x16_bf16 v[0:15], v[68:71], v[72:75], v[0:15]
  ds_read_b64_tr_b16 v[56:57], v128 offset:8192
  ds_read_b64_tr_b16 v[58:59], v128 offset:9216
  ds_read_b128 v[60:63], v129 offset:16384
  ds_read_b128 v[64:67], v129 offset:18432
  v_mfma_f32_32x32x16_bf16 v[16:31], v[68:71], v[76:79], v[16:31]
  ds_read_b64_tr_b16 v[68:69], v128 offset:12288
  ds_read_b64_tr_b16 v[70:71], v128 offset:13312
  s_waitcnt lgkmcnt(10)
  ds_read_b128 v[72:75], v129 offset:17408
  ds_read_b128 v[76:79], v129 offset:19456
  v_mfma_f32_32x32x16_bf16 v[0:15], v[32:35], v[36:39], v[0:15]
  v_mfma_f32_32x32x16_bf16 v[16:31], v[32:35], v[40:43], v[16:31]
  s_waitcnt lgkmcnt(9)
  v_mfma_f32_32x32x16_bf16 v[0:15], v[44:47], v[48:51], v[0:15]
  s_waitcnt lgkmcnt(8)
  v_mfma_f32_32x32x16_bf16 v[16:31], v[44:47], v[52:55], v[16:31]
  s_add_u32 s34, s34, 20480
  s_cmp_eq_u32 s34, 163840
  s_cselect_b32 s34, 81920, s34
  s_cmp_eq_u32 s33, 0
  s_cselect_b32 s35, 16384, s33
  s_add_u32 s35, s35, 16384
  s_cmp_eq_u32 s35, 81920
  s_cselect_b32 s33, 0, s35
  v_add_u32 v128, s33, v130
  v_add_u32 v129, s34, v161
  s_waitcnt lgkmcnt(0)
  s_cmp_lt_u32 s59, 16
  s_cbranch_scc0 concat_heads__gqa_block_cached__gqa_block_cached__near_ridge_kernel_onow0
  s_lshr_b32 s35, s59, 2
  s_add_u32 s35, s35, s100
  s_and_b32 s35, s35, 3
  s_lshl_b32 s35, s35, 1
  s_add_u32 s35, s35, s61
  s_lshl_b32 s35, s35, 17
  s_and_b32 s36, s59, 3
  s_lshl_b32 s36, s36, 15
  s_add_u32 s35, s35, s36
  s_add_u32 s35, s35, s43
  s_add_u32 s36, s4, s42
  s_add_u32 m0, s36, 0
  s_add_u32 s38, s35, 0
  buffer_load_dwordx4 v159, s[8:11], s38 offen nt lds
  s_add_u32 m0, s36, 1024
  s_add_u32 s38, s35, 4096
  buffer_load_dwordx4 v159, s[8:11], s38 offen nt lds
  s_add_u32 s59, s59, 1
  s_cmp_eq_u32 s4, 0
  s_cselect_b32 s35, 16384, s4
  s_add_u32 s35, s35, 16384
  s_cmp_eq_u32 s35, 81920
  s_cselect_b32 s4, 0, s35
concat_heads__gqa_block_cached__gqa_block_cached__near_ridge_kernel_onow0:
  s_cmp_lt_u32 s39, 13
  s_cbranch_scc0 concat_heads__gqa_block_cached__gqa_block_cached__near_ridge_kernel_owt0
  s_waitcnt vmcnt(4)
concat_heads__gqa_block_cached__gqa_block_cached__near_ridge_kernel_ogo0:
  s_add_u32 s39, s39, 1
  s_cmp_lt_u32 s39, 16
  s_cbranch_scc1 concat_heads__gqa_block_cached__gqa_block_cached__near_ridge_kernel_oloop0
  v_mfma_f32_32x32x16_bf16 v[0:15], v[56:59], v[60:63], v[0:15]
  v_mfma_f32_32x32x16_bf16 v[16:31], v[56:59], v[64:67], v[16:31]
  v_mfma_f32_32x32x16_bf16 v[0:15], v[68:71], v[72:75], v[0:15]
  v_mfma_f32_32x32x16_bf16 v[16:31], v[68:71], v[76:79], v[16:31]
  s_lshr_b32 s31, s44, 3
  s_mul_i32 s36, s31, 2621440
  s_mul_i32 s35, s47, 10240
  s_add_u32 s36, s36, s35
  s_mov_b32 s32, 7
  s_nop 7
  s_add_u32 s35, s47, 3
  s_and_b32 s35, s35, 3
  s_cmp_eq_u32 s35, s31
  s_cselect_b32 s32, 0, s32
  s_cbranch_scc1 concat_heads__gqa_block_cached__gqa_block_cached__near_ridge_kernel_pown0_0
  v_cvt_pk_bf16_f32 v64, v0, v1
  v_cvt_pk_bf16_f32 v65, v2, v3
  v_cvt_pk_bf16_f32 v66, v4, v5
  v_cvt_pk_bf16_f32 v67, v6, v7
  v_cvt_pk_bf16_f32 v68, v8, v9
  v_cvt_pk_bf16_f32 v69, v10, v11
  v_cvt_pk_bf16_f32 v70, v12, v13
  v_cvt_pk_bf16_f32 v71, v14, v15
  s_add_u32 s37, s36, 6144
  buffer_store_dwordx4 v[64:67], v161, s[12:15], s37 offen sc1
  s_add_u32 s37, s36, 7168
  buffer_store_dwordx4 v[68:71], v161, s[12:15], s37 offen sc1
concat_heads__gqa_block_cached__gqa_block_cached__near_ridge_kernel_pown0_0:
  s_cmp_eq_u32 s47, s31
  s_cselect_b32 s32, 1, s32
  s_cbranch_scc1 concat_heads__gqa_block_cached__gqa_block_cached__near_ridge_kernel_pown0_1
  v_cvt_pk_bf16_f32 v72, v16, v17
  v_cvt_pk_bf16_f32 v73, v18, v19
  v_cvt_pk_bf16_f32 v74, v20, v21
  v_cvt_pk_bf16_f32 v75, v22, v23
  v_cvt_pk_bf16_f32 v76, v24, v25
  v_cvt_pk_bf16_f32 v77, v26, v27
  v_cvt_pk_bf16_f32 v78, v28, v29
  v_cvt_pk_bf16_f32 v79, v30, v31
  s_add_u32 s37, s36, 8192
  buffer_store_dwordx4 v[72:75], v161, s[12:15], s37 offen sc1
  s_add_u32 s37, s36, 9216
  buffer_store_dwordx4 v[76:79], v161, s[12:15], s37 offen sc1
concat_heads__gqa_block_cached__gqa_block_cached__near_ridge_kernel_pown0_1:
  s_mov_b32 s39, 1
  s_branch concat_heads__gqa_block_cached__gqa_block_cached__near_ridge_kernel_pdone
concat_heads__gqa_block_cached__gqa_block_cached__near_ridge_kernel_owt0:
  s_waitcnt vmcnt(0)
  s_branch concat_heads__gqa_block_cached__gqa_block_cached__near_ridge_kernel_ogo0
concat_heads__gqa_block_cached__gqa_block_cached__near_ridge_kernel_og1:
  v_add_u32 v128, s33, v130
  v_add_u32 v129, s34, v161
  s_lshr_b32 s35, s59, 2
  s_add_u32 s35, s35, s100
  s_and_b32 s35, s35, 3
  s_lshl_b32 s35, s35, 1
  s_add_u32 s35, s35, s61
  s_lshl_b32 s35, s35, 17
  s_and_b32 s36, s59, 3
  s_lshl_b32 s36, s36, 15
  s_add_u32 s35, s35, s36
  s_add_u32 s35, s35, s43
  s_add_u32 s36, s4, s42
  s_add_u32 m0, s36, 0
  s_add_u32 s38, s35, 0
  buffer_load_dwordx4 v159, s[8:11], s38 offen nt lds
  s_add_u32 m0, s36, 1024
  s_add_u32 s38, s35, 4096
  buffer_load_dwordx4 v159, s[8:11], s38 offen nt lds
  s_add_u32 s59, s59, 1
  s_cmp_eq_u32 s4, 0
  s_cselect_b32 s35, 16384, s4
  s_add_u32 s35, s35, 16384
  s_cmp_eq_u32 s35, 81920
  s_cselect_b32 s4, 0, s35
  ds_read_b64_tr_b16 v[48:49], v128 offset:0
  ds_read_b64_tr_b16 v[50:51], v128 offset:1024
  ds_read_b128 v[52:55], v129 offset:0
  ds_read_b128 v[56:59], v129 offset:2048
  ds_read_b128 v[60:63], v129 offset:4096
  ds_read_b64_tr_b16 v[64:65], v128 offset:4096
  ds_read_b64_tr_b16 v[66:67], v128 offset:5120
  ds_read_b128 v[68:71], v129 offset:1024
  ds_read_b128 v[72:75], v129 offset:3072
  ds_read_b128 v[76:79], v129 offset:5120
  s_waitcnt lgkmcnt(7)
  v_mfma_f32_32x32x16_bf16 v[0:15], v[48:51], v[52:55], 0
  ds_read_b64_tr_b16 v[80:81], v128 offset:8192
  ds_read_b64_tr_b16 v[82:83], v128 offset:9216
  ds_read_b128 v[84:87], v129 offset:10240
  ds_read_b128 v[88:91], v129 offset:12288
  s_waitcnt lgkmcnt(10)
  v_mfma_f32_32x32x16_bf16 v[16:31], v[48:51], v[56:59], 0
  ds_read_b128 v[92:95], v129 offset:14336
  ds_read_b64_tr_b16 v[96:97], v128 offset:12288
  ds_read_b64_tr_b16 v[98:99], v128 offset:13312
  ds_read_b128 v[100:103], v129 offset:11264
  s_waitcnt lgkmcnt(13)
  v_mfma_f32_32x32x16_bf16 v[32:47], v[48:51], v[60:63], 0
  ds_read_b128 v[104:107], v129 offset:13312
  s_waitcnt lgkmcnt(9)
  ds_read_b128 v[108:111], v129 offset:15360
  v_mfma_f32_32x32x16_bf16 v[0:15], v[64:67], v[68:71], v[0:15]
  v_mfma_f32_32x32x16_bf16 v[16:31], v[64:67], v[72:75], v[16:31]
  v_mfma_f32_32x32x16_bf16 v[32:47], v[64:67], v[76:79], v[32:47]
  s_add_u32 s34, s34, 20480
  s_cmp_eq_u32 s34, 163840
  s_cselect_b32 s34, 81920, s34
  s_cmp_eq_u32 s33, 0
  s_cselect_b32 s35, 16384, s33
  s_add_u32 s35, s35, 16384
  s_cmp_eq_u32 s35, 81920
  s_cselect_b32 s33, 0, s35
  v_add_u32 v128, s33, v130
  v_add_u32 v129, s34, v161
  s_waitcnt lgkmcnt(0)
  s_mov_b32 s39, 1
  s_waitcnt vmcnt(2)
  s_barrier
concat_heads__gqa_block_cached__gqa_block_cached__near_ridge_kernel_oloop1:
  s_cmp_lt_u32 s59, 16
  s_cbranch_scc0 concat_heads__gqa_block_cached__gqa_block_cached__near_ridge_kernel_onow1
  s_lshr_b32 s35, s59, 2
  s_add_u32 s35, s35, s100
  s_and_b32 s35, s35, 3
  s_lshl_b32 s35, s35, 1
  s_add_u32 s35, s35, s61
  s_lshl_b32 s35, s35, 17
  s_and_b32 s36, s59, 3
  s_lshl_b32 s36, s36, 15
  s_add_u32 s35, s35, s36
  s_add_u32 s35, s35, s43
  s_add_u32 s36, s4, s42
  s_add_u32 m0, s36, 0
  s_add_u32 s38, s35, 0
  buffer_load_dwordx4 v159, s[8:11], s38 offen nt lds
  s_add_u32 m0, s36, 1024
  s_add_u32 s38, s35, 4096
  buffer_load_dwordx4 v159, s[8:11], s38 offen nt lds
  s_add_u32 s59, s59, 1
  s_cmp_eq_u32 s4, 0
  s_cselect_b32 s35, 16384, s4
  s_add_u32 s35, s35, 16384
  s_cmp_eq_u32 s35, 81920
  s_cselect_b32 s4, 0, s35
concat_heads__gqa_block_cached__gqa_block_cached__near_ridge_kernel_onow1:
  v_mfma_f32_32x32x16_bf16 v[0:15], v[80:83], v[84:87], v[0:15]
  ds_read_b64_tr_b16 v[48:49], v128 offset:0
  ds_read_b64_tr_b16 v[50:51], v128 offset:1024
  ds_read_b128 v[52:55], v129 offset:0
  ds_read_b128 v[56:59], v129 offset:2048
  v_mfma_f32_32x32x16_bf16 v[16:31], v[80:83], v[88:91], v[16:31]
  ds_read_b128 v[60:63], v129 offset:4096
  ds_read_b64_tr_b16 v[64:65], v128 offset:4096
  ds_read_b64_tr_b16 v[66:67], v128 offset:5120
  ds_read_b128 v[68:71], v129 offset:1024
  v_mfma_f32_32x32x16_bf16 v[32:47], v[80:83], v[92:95], v[32:47]
  ds_read_b128 v[72:75], v129 offset:3072
  ds_read_b128 v[76:79], v129 offset:5120
  ds_read_b64_tr_b16 v[80:81], v128 offset:8192
  ds_read_b64_tr_b16 v[82:83], v128 offset:9216
  v_mfma_f32_32x32x16_bf16 v[0:15], v[96:99], v[100:103], v[0:15]
  ds_read_b128 v[84:87], v129 offset:10240
  ds_read_b128 v[88:91], v129 offset:12288
  s_waitcnt lgkmcnt(10)
  ds_read_b128 v[92:95], v129 offset:14336
  v_mfma_f32_32x32x16_bf16 v[16:31], v[96:99], v[104:107], v[16:31]
  v_mfma_f32_32x32x16_bf16 v[32:47], v[96:99], v[108:111], v[32:47]
  ds_read_b64_tr_b16 v[96:97], v128 offset:12288
  ds_read_b64_tr_b16 v[98:99], v128 offset:13312
  ds_read_b128 v[100:103], v129 offset:11264
  s_waitcnt lgkmcnt(6)
  ds_read_b128 v[104:107], v129 offset:13312
  v_mfma_f32_32x32x16_bf16 v[0:15], v[48:51], v[52:55], v[0:15]
  ds_read_b128 v[108:111], v129 offset:15360
  v_mfma_f32_32x32x16_bf16 v[16:31], v[48:51], v[56:59], v[16:31]
  v_mfma_f32_32x32x16_bf16 v[32:47], v[48:51], v[60:63], v[32:47]
  v_mfma_f32_32x32x16_bf16 v[0:15], v[64:67], v[68:71], v[0:15]
  v_mfma_f32_32x32x16_bf16 v[16:31], v[64:67], v[72:75], v[16:31]
  v_mfma_f32_32x32x16_bf16 v[32:47], v[64:67], v[76:79], v[32:47]
  s_waitcnt lgkmcnt(0)
  s_cmp_lt_u32 s39, 13
  s_cbranch_scc0 concat_heads__gqa_block_cached__gqa_block_cached__near_ridge_kernel_owt1
  s_waitcnt vmcnt(4)
concat_heads__gqa_block_cached__gqa_block_cached__near_ridge_kernel_ogo1:
  s_cmp_eq_u32 s39, 15
  s_cbranch_scc1 concat_heads__gqa_block_cached__gqa_block_cached__near_ridge_kernel_oend1
  s_barrier
  s_add_u32 s34, s34, 20480
  s_cmp_eq_u32 s34, 163840
  s_cselect_b32 s34, 81920, s34
  s_cmp_eq_u32 s33, 0
  s_cselect_b32 s35, 16384, s33
  s_add_u32 s35, s35, 16384
  s_cmp_eq_u32 s35, 81920
  s_cselect_b32 s33, 0, s35
  v_add_u32 v128, s33, v130
  v_add_u32 v129, s34, v161
  s_add_u32 s39, s39, 1
  s_branch concat_heads__gqa_block_cached__gqa_block_cached__near_ridge_kernel_oloop1
concat_heads__gqa_block_cached__gqa_block_cached__near_ridge_kernel_oend1:
  v_mfma_f32_32x32x16_bf16 v[0:15], v[80:83], v[84:87], v[0:15]
  v_mfma_f32_32x32x16_bf16 v[16:31], v[80:83], v[88:91], v[16:31]
  v_mfma_f32_32x32x16_bf16 v[32:47], v[80:83], v[92:95], v[32:47]
  v_mfma_f32_32x32x16_bf16 v[0:15], v[96:99], v[100:103], v[0:15]
  v_mfma_f32_32x32x16_bf16 v[16:31], v[96:99], v[104:107], v[16:31]
  v_mfma_f32_32x32x16_bf16 v[32:47], v[96:99], v[108:111], v[32:47]
  s_lshr_b32 s31, s44, 3
  s_mul_i32 s36, s31, 2621440
  s_mul_i32 s35, s47, 10240
  s_add_u32 s36, s36, s35
  s_mov_b32 s32, 7
  s_nop 7
  s_add_u32 s35, s47, 0
  s_and_b32 s35, s35, 3
  s_cmp_eq_u32 s35, s31
  s_cselect_b32 s32, 0, s32
  s_cbranch_scc1 concat_heads__gqa_block_cached__gqa_block_cached__near_ridge_kernel_pown1_0
  v_cvt_pk_bf16_f32 v64, v0, v1
  v_cvt_pk_bf16_f32 v65, v2, v3
  v_cvt_pk_bf16_f32 v66, v4, v5
  v_cvt_pk_bf16_f32 v67, v6, v7
  v_cvt_pk_bf16_f32 v68, v8, v9
  v_cvt_pk_bf16_f32 v69, v10, v11
  v_cvt_pk_bf16_f32 v70, v12, v13
  v_cvt_pk_bf16_f32 v71, v14, v15
  s_add_u32 s37, s36, 0
  buffer_store_dwordx4 v[64:67], v161, s[12:15], s37 offen sc1
  s_add_u32 s37, s36, 1024
  buffer_store_dwordx4 v[68:71], v161, s[12:15], s37 offen sc1
concat_heads__gqa_block_cached__gqa_block_cached__near_ridge_kernel_pown1_0:
  s_add_u32 s35, s47, 1
  s_and_b32 s35, s35, 3
  s_cmp_eq_u32 s35, s31
  s_cselect_b32 s32, 1, s32
  s_cbranch_scc1 concat_heads__gqa_block_cached__gqa_block_cached__near_ridge_kernel_pown1_1
  v_cvt_pk_bf16_f32 v72, v16, v17
  v_cvt_pk_bf16_f32 v73, v18, v19
  v_cvt_pk_bf16_f32 v74, v20, v21
  v_cvt_pk_bf16_f32 v75, v22, v23
  v_cvt_pk_bf16_f32 v76, v24, v25
  v_cvt_pk_bf16_f32 v77, v26, v27
  v_cvt_pk_bf16_f32 v78, v28, v29
  v_cvt_pk_bf16_f32 v79, v30, v31
  s_add_u32 s37, s36, 2048
  buffer_store_dwordx4 v[72:75], v161, s[12:15], s37 offen sc1
  s_add_u32 s37, s36, 3072
  buffer_store_dwordx4 v[76:79], v161, s[12:15], s37 offen sc1
concat_heads__gqa_block_cached__gqa_block_cached__near_ridge_kernel_pown1_1:
  s_add_u32 s35, s47, 2
  s_and_b32 s35, s35, 3
  s_cmp_eq_u32 s35, s31
  s_cselect_b32 s32, 2, s32
  s_cbranch_scc1 concat_heads__gqa_block_cached__gqa_block_cached__near_ridge_kernel_pown1_2
  v_cvt_pk_bf16_f32 v80, v32, v33
  v_cvt_pk_bf16_f32 v81, v34, v35
  v_cvt_pk_bf16_f32 v82, v36, v37
  v_cvt_pk_bf16_f32 v83, v38, v39
  v_cvt_pk_bf16_f32 v84, v40, v41
  v_cvt_pk_bf16_f32 v85, v42, v43
  v_cvt_pk_bf16_f32 v86, v44, v45
  v_cvt_pk_bf16_f32 v87, v46, v47
  s_add_u32 s37, s36, 4096
  buffer_store_dwordx4 v[80:83], v161, s[12:15], s37 offen sc1
  s_add_u32 s37, s36, 5120
  buffer_store_dwordx4 v[84:87], v161, s[12:15], s37 offen sc1
concat_heads__gqa_block_cached__gqa_block_cached__near_ridge_kernel_pown1_2:
  s_mov_b32 s39, 0
  s_branch concat_heads__gqa_block_cached__gqa_block_cached__near_ridge_kernel_pdone
concat_heads__gqa_block_cached__gqa_block_cached__near_ridge_kernel_owt1:
  s_waitcnt vmcnt(0)
  s_branch concat_heads__gqa_block_cached__gqa_block_cached__near_ridge_kernel_ogo1
concat_heads__gqa_block_cached__gqa_block_cached__near_ridge_kernel_oload:
  s_sub_u32 s41, s28, 8
  s_lshl_b32 s35, s100, 1
  s_sub_u32 s61, s44, s35
  s_add_u32 s61, s61, s41
  s_waitcnt lgkmcnt(0)
  s_barrier
  s_waitcnt vmcnt(0)
  s_barrier
  s_cmp_eq_u32 s28, 8
  s_cbranch_scc0 concat_heads__gqa_block_cached__gqa_block_cached__near_ridge_kernel_nopub
  s_lshl_b32 s35, s2, 8
  v_mov_b32 v154, s35
  v_mov_b32 v155, 1
  s_mov_b64 exec, 1
  buffer_store_dword v155, v154, s[20:23], 0 offen sc1
  s_mov_b64 exec, -1
concat_heads__gqa_block_cached__gqa_block_cached__near_ridge_kernel_nopub:
  v_cmp_gt_u32 vcc, 16, v166
  s_nop 4
  s_cbranch_vccz concat_heads__gqa_block_cached__gqa_block_cached__near_ridge_kernel_initok
  s_lshl_b32 s35, s45, 3
  s_add_u32 s35, s35, s46
  s_lshl_b32 s35, s35, 2
  v_mov_b32 v131, s35
  s_mov_b32 s40, 65536
concat_heads__gqa_block_cached__gqa_block_cached__near_ridge_kernel_polli:
  buffer_load_dword v166, v131, s[96:99], 0 offen sc1
  s_waitcnt vmcnt(0)
  v_cmp_gt_u32 vcc, 16, v166
  s_nop 4
  s_cbranch_vccz concat_heads__gqa_block_cached__gqa_block_cached__near_ridge_kernel_initok
  s_sub_u32 s40, s40, 1
  s_cmp_lg_u32 s40, 0
  s_cbranch_scc1 concat_heads__gqa_block_cached__gqa_block_cached__near_ridge_kernel_polli
concat_heads__gqa_block_cached__gqa_block_cached__near_ridge_kernel_initok:
  s_andn2_b32 s35, s2, 0x18
  v_lshlrev_b32 v131, 3, v162
  v_or_b32 v131, s35, v131
  v_lshlrev_b32 v131, 8, v131
  s_mov_b32 s40, 65536
  s_mov_b64 exec, 15
concat_heads__gqa_block_cached__gqa_block_cached__near_ridge_kernel_pollo:
  buffer_load_dword v132, v131, s[20:23], 0 offen sc1
  s_waitcnt vmcnt(0)
  v_cmp_ne_u32 vcc, 1, v132
  s_nop 4
  s_cbranch_vccz concat_heads__gqa_block_cached__gqa_block_cached__near_ridge_kernel_polloko
  s_sub_u32 s40, s40, 1
  s_cmp_lg_u32 s40, 0
  s_cbranch_scc1 concat_heads__gqa_block_cached__gqa_block_cached__near_ridge_kernel_pollo
concat_heads__gqa_block_cached__gqa_block_cached__near_ridge_kernel_polloko:
  s_waitcnt vmcnt(0)
  s_mov_b64 exec, -1
  s_mov_b32 s59, 4
  s_mov_b32 s5, 81920
  s_lshr_b32 s35, s59, 2
  s_add_u32 s35, s35, s100
  s_and_b32 s35, s35, 3
  s_lshl_b32 s35, s35, 1
  s_add_u32 s37, s35, s61
  s_and_b32 s39, s59, 3
  s_lshl_b32 s35, s37, 13
  s_lshl_b32 s36, s39, 11
  s_add_u32 s35, s35, s36
  s_mul_i32 s36, s41, 10240
  s_add_u32 s36, s36, s5
  s_add_u32 m0, s36, 0
  s_add_u32 s38, s35, 0
  buffer_load_dwordx4 v161, s[24:27], s38 offen sc1 lds
  s_add_u32 m0, s36, 1024
  s_add_u32 s38, s35, 1024
  buffer_load_dwordx4 v161, s[24:27], s38 offen sc1 lds
  s_add_u32 m0, s36, 2048
  s_add_u32 s38, s35, 262144
  buffer_load_dwordx4 v161, s[24:27], s38 offen sc1 lds
  s_add_u32 m0, s36, 3072
  s_add_u32 s38, s35, 263168
  buffer_load_dwordx4 v161, s[24:27], s38 offen sc1 lds
  s_add_u32 m0, s36, 4096
  s_add_u32 s38, s35, 524288
  buffer_load_dwordx4 v161, s[24:27], s38 offen sc1 lds
  s_add_u32 m0, s36, 5120
  s_add_u32 s38, s35, 525312
  buffer_load_dwordx4 v161, s[24:27], s38 offen sc1 lds
  s_add_u32 m0, s36, 6144
  s_add_u32 s38, s35, 786432
  buffer_load_dwordx4 v161, s[24:27], s38 offen sc1 lds
  s_add_u32 m0, s36, 7168
  s_add_u32 s38, s35, 787456
  buffer_load_dwordx4 v161, s[24:27], s38 offen sc1 lds
  s_add_u32 m0, s36, 8192
  s_add_u32 s38, s35, 1048576
  buffer_load_dwordx4 v161, s[24:27], s38 offen sc1 lds
  s_add_u32 m0, s36, 9216
  s_add_u32 s38, s35, 1049600
  buffer_load_dwordx4 v161, s[24:27], s38 offen sc1 lds
  s_add_u32 s59, s59, 1
  s_add_u32 s5, s5, 20480
  s_cmp_eq_u32 s5, 163840
  s_cselect_b32 s5, 81920, s5
  s_barrier
  s_lshr_b32 s35, s59, 2
  s_add_u32 s35, s35, s100
  s_and_b32 s35, s35, 3
  s_lshl_b32 s35, s35, 1
  s_add_u32 s37, s35, s61
  s_and_b32 s39, s59, 3
  s_lshl_b32 s35, s37, 13
  s_lshl_b32 s36, s39, 11
  s_add_u32 s35, s35, s36
  s_mul_i32 s36, s41, 10240
  s_add_u32 s36, s36, s5
  s_add_u32 m0, s36, 0
  s_add_u32 s38, s35, 0
  buffer_load_dwordx4 v161, s[24:27], s38 offen sc1 lds
  s_add_u32 m0, s36, 1024
  s_add_u32 s38, s35, 1024
  buffer_load_dwordx4 v161, s[24:27], s38 offen sc1 lds
  s_add_u32 m0, s36, 2048
  s_add_u32 s38, s35, 262144
  buffer_load_dwordx4 v161, s[24:27], s38 offen sc1 lds
  s_add_u32 m0, s36, 3072
  s_add_u32 s38, s35, 263168
  buffer_load_dwordx4 v161, s[24:27], s38 offen sc1 lds
  s_add_u32 m0, s36, 4096
  s_add_u32 s38, s35, 524288
  buffer_load_dwordx4 v161, s[24:27], s38 offen sc1 lds
  s_add_u32 m0, s36, 5120
  s_add_u32 s38, s35, 525312
  buffer_load_dwordx4 v161, s[24:27], s38 offen sc1 lds
  s_add_u32 m0, s36, 6144
  s_add_u32 s38, s35, 786432
  buffer_load_dwordx4 v161, s[24:27], s38 offen sc1 lds
  s_add_u32 m0, s36, 7168
  s_add_u32 s38, s35, 787456
  buffer_load_dwordx4 v161, s[24:27], s38 offen sc1 lds
  s_add_u32 m0, s36, 8192
  s_add_u32 s38, s35, 1048576
  buffer_load_dwordx4 v161, s[24:27], s38 offen sc1 lds
  s_add_u32 m0, s36, 9216
  s_add_u32 s38, s35, 1049600
  buffer_load_dwordx4 v161, s[24:27], s38 offen sc1 lds
  s_add_u32 s59, s59, 1
  s_add_u32 s5, s5, 20480
  s_cmp_eq_u32 s5, 163840
  s_cselect_b32 s5, 81920, s5
concat_heads__gqa_block_cached__gqa_block_cached__near_ridge_kernel_lloop:
  s_waitcnt vmcnt(20)
  s_barrier
  s_lshr_b32 s35, s59, 2
  s_add_u32 s35, s35, s100
  s_and_b32 s35, s35, 3
  s_lshl_b32 s35, s35, 1
  s_add_u32 s37, s35, s61
  s_and_b32 s39, s59, 3
  s_lshl_b32 s35, s37, 13
  s_lshl_b32 s36, s39, 11
  s_add_u32 s35, s35, s36
  s_mul_i32 s36, s41, 10240
  s_add_u32 s36, s36, s5
  s_add_u32 m0, s36, 0
  s_add_u32 s38, s35, 0
  buffer_load_dwordx4 v161, s[24:27], s38 offen sc1 lds
  s_add_u32 m0, s36, 1024
  s_add_u32 s38, s35, 1024
  buffer_load_dwordx4 v161, s[24:27], s38 offen sc1 lds
  s_add_u32 m0, s36, 2048
  s_add_u32 s38, s35, 262144
  buffer_load_dwordx4 v161, s[24:27], s38 offen sc1 lds
  s_add_u32 m0, s36, 3072
  s_add_u32 s38, s35, 263168
  buffer_load_dwordx4 v161, s[24:27], s38 offen sc1 lds
  s_add_u32 m0, s36, 4096
  s_add_u32 s38, s35, 524288
  buffer_load_dwordx4 v161, s[24:27], s38 offen sc1 lds
  s_add_u32 m0, s36, 5120
  s_add_u32 s38, s35, 525312
  buffer_load_dwordx4 v161, s[24:27], s38 offen sc1 lds
  s_add_u32 m0, s36, 6144
  s_add_u32 s38, s35, 786432
  buffer_load_dwordx4 v161, s[24:27], s38 offen sc1 lds
  s_add_u32 m0, s36, 7168
  s_add_u32 s38, s35, 787456
  buffer_load_dwordx4 v161, s[24:27], s38 offen sc1 lds
  s_add_u32 m0, s36, 8192
  s_add_u32 s38, s35, 1048576
  buffer_load_dwordx4 v161, s[24:27], s38 offen sc1 lds
  s_add_u32 m0, s36, 9216
  s_add_u32 s38, s35, 1049600
  buffer_load_dwordx4 v161, s[24:27], s38 offen sc1 lds
  s_add_u32 s59, s59, 1
  s_add_u32 s5, s5, 20480
  s_cmp_eq_u32 s5, 163840
  s_cselect_b32 s5, 81920, s5
  s_cmp_lt_u32 s59, 16
  s_cbranch_scc1 concat_heads__gqa_block_cached__gqa_block_cached__near_ridge_kernel_lloop
  s_waitcnt vmcnt(20)
  s_barrier
  s_waitcnt vmcnt(10)
  s_barrier
  s_waitcnt vmcnt(0)
  s_barrier
  s_mov_b32 s32, 7
concat_heads__gqa_block_cached__gqa_block_cached__near_ridge_kernel_pdone:
  s_waitcnt vmcnt(0)
  s_barrier
  s_cmp_eq_u32 s28, 8
  s_cbranch_scc0 concat_heads__gqa_block_cached__gqa_block_cached__near_ridge_kernel_nopoll
  s_lshl_b32 s35, s2, 8
  s_add_u32 s35, s35, 128
  v_mov_b32 v154, s35
  v_mov_b32 v155, 1
  s_mov_b64 exec, 1
  buffer_store_dword v155, v154, s[20:23], 0 offen sc1
  s_mov_b64 exec, -1
  s_andn2_b32 s35, s2, 3
  v_or_b32 v131, s35, v162
  v_lshlrev_b32 v131, 8, v131
  v_add_u32 v131, 128, v131
  s_mov_b32 s40, 65536
  s_mov_b64 exec, 15
concat_heads__gqa_block_cached__gqa_block_cached__near_ridge_kernel_pollp:
  buffer_load_dword v132, v131, s[20:23], 0 offen sc1
  s_waitcnt vmcnt(0)
  v_cmp_ne_u32 vcc, 1, v132
  s_nop 4
  s_cbranch_vccz concat_heads__gqa_block_cached__gqa_block_cached__near_ridge_kernel_pollokp
  s_sub_u32 s40, s40, 1
  s_cmp_lg_u32 s40, 0
  s_cbranch_scc1 concat_heads__gqa_block_cached__gqa_block_cached__near_ridge_kernel_pollp
concat_heads__gqa_block_cached__gqa_block_cached__near_ridge_kernel_pollokp:
  s_waitcnt vmcnt(0)
  s_mov_b64 exec, -1
concat_heads__gqa_block_cached__gqa_block_cached__near_ridge_kernel_nopoll:
  s_barrier
  s_cmp_eq_u32 s32, 7
  s_cbranch_scc1 concat_heads__gqa_block_cached__gqa_block_cached__near_ridge_kernel_odone
  s_mul_i32 s35, s39, 3
  s_add_u32 s35, s35, s32
  s_mul_i32 s36, s47, 5
  s_add_u32 s36, s36, s35
  s_lshl_b32 s36, s36, 11
  s_add_u32 s37, s31, 1
  s_and_b32 s37, s37, 3
  s_mul_i32 s37, s37, 2621440
  s_add_u32 s37, s37, s36
  s_add_u32 s38, s37, 0
  buffer_load_dwordx4 v[64:67], v161, s[12:15], s38 offen sc1
  s_add_u32 s38, s37, 1024
  buffer_load_dwordx4 v[68:71], v161, s[12:15], s38 offen sc1
  s_add_u32 s37, s31, 2
  s_and_b32 s37, s37, 3
  s_mul_i32 s37, s37, 2621440
  s_add_u32 s37, s37, s36
  s_add_u32 s38, s37, 0
  buffer_load_dwordx4 v[72:75], v161, s[12:15], s38 offen sc1
  s_add_u32 s38, s37, 1024
  buffer_load_dwordx4 v[76:79], v161, s[12:15], s38 offen sc1
  s_add_u32 s37, s31, 3
  s_and_b32 s37, s37, 3
  s_mul_i32 s37, s37, 2621440
  s_add_u32 s37, s37, s36
  s_add_u32 s38, s37, 0
  buffer_load_dwordx4 v[80:83], v161, s[12:15], s38 offen sc1
  s_add_u32 s38, s37, 1024
  buffer_load_dwordx4 v[84:87], v161, s[12:15], s38 offen sc1
  s_mul_i32 s36, s46, 160
  s_lshl_b32 s35, s35, 5
  s_add_u32 s35, s35, s36
  s_lshl_b32 s35, s35, 11
  s_lshl_b32 s37, s45, 10
  s_add_u32 s35, s35, s37
  s_lshl_b32 s37, s100, 8
  s_add_u32 s35, s35, s37
  s_lshl_b32 s37, s47, 6
  s_add_u32 s35, s35, s37
  v_and_b32 v128, 31, v162
  v_lshlrev_b32 v128, 11, v128
  v_lshrrev_b32 v129, 5, v162
  v_lshl_add_u32 v128, v129, 4, v128
  s_cmp_eq_u32 s32, 0
  s_cbranch_scc0 concat_heads__gqa_block_cached__gqa_block_cached__near_ridge_kernel_mvown0
  v_mov_b32 v96, v0
  v_mov_b32 v97, v1
  v_mov_b32 v98, v2
  v_mov_b32 v99, v3
  v_mov_b32 v100, v4
  v_mov_b32 v101, v5
  v_mov_b32 v102, v6
  v_mov_b32 v103, v7
  v_mov_b32 v104, v8
  v_mov_b32 v105, v9
  v_mov_b32 v106, v10
  v_mov_b32 v107, v11
  v_mov_b32 v108, v12
  v_mov_b32 v109, v13
  v_mov_b32 v110, v14
  v_mov_b32 v111, v15
concat_heads__gqa_block_cached__gqa_block_cached__near_ridge_kernel_mvown0:
  s_cmp_eq_u32 s32, 1
  s_cbranch_scc0 concat_heads__gqa_block_cached__gqa_block_cached__near_ridge_kernel_mvown1
  v_mov_b32 v96, v16
  v_mov_b32 v97, v17
  v_mov_b32 v98, v18
  v_mov_b32 v99, v19
  v_mov_b32 v100, v20
  v_mov_b32 v101, v21
  v_mov_b32 v102, v22
  v_mov_b32 v103, v23
  v_mov_b32 v104, v24
  v_mov_b32 v105, v25
  v_mov_b32 v106, v26
  v_mov_b32 v107, v27
  v_mov_b32 v108, v28
  v_mov_b32 v109, v29
  v_mov_b32 v110, v30
  v_mov_b32 v111, v31
concat_heads__gqa_block_cached__gqa_block_cached__near_ridge_kernel_mvown1:
  s_cmp_eq_u32 s32, 2
  s_cbranch_scc0 concat_heads__gqa_block_cached__gqa_block_cached__near_ridge_kernel_mvown2
  v_mov_b32 v96, v32
  v_mov_b32 v97, v33
  v_mov_b32 v98, v34
  v_mov_b32 v99, v35
  v_mov_b32 v100, v36
  v_mov_b32 v101, v37
  v_mov_b32 v102, v38
  v_mov_b32 v103, v39
  v_mov_b32 v104, v40
  v_mov_b32 v105, v41
  v_mov_b32 v106, v42
  v_mov_b32 v107, v43
  v_mov_b32 v108, v44
  v_mov_b32 v109, v45
  v_mov_b32 v110, v46
  v_mov_b32 v111, v47
concat_heads__gqa_block_cached__gqa_block_cached__near_ridge_kernel_mvown2:
  s_waitcnt vmcnt(4)
  v_lshlrev_b32 v112, 16, v64
  v_and_b32 v113, 0xffff0000, v64
  v_add_f32 v96, v96, v112
  v_add_f32 v97, v97, v113
  v_lshlrev_b32 v112, 16, v65
  v_and_b32 v113, 0xffff0000, v65
  v_add_f32 v98, v98, v112
  v_add_f32 v99, v99, v113
  v_lshlrev_b32 v112, 16, v66
  v_and_b32 v113, 0xffff0000, v66
  v_add_f32 v100, v100, v112
  v_add_f32 v101, v101, v113
  v_lshlrev_b32 v112, 16, v67
  v_and_b32 v113, 0xffff0000, v67
  v_add_f32 v102, v102, v112
  v_add_f32 v103, v103, v113
  v_lshlrev_b32 v112, 16, v68
  v_and_b32 v113, 0xffff0000, v68
  v_add_f32 v104, v104, v112
  v_add_f32 v105, v105, v113
  v_lshlrev_b32 v112, 16, v69
  v_and_b32 v113, 0xffff0000, v69
  v_add_f32 v106, v106, v112
  v_add_f32 v107, v107, v113
  v_lshlrev_b32 v112, 16, v70
  v_and_b32 v113, 0xffff0000, v70
  v_add_f32 v108, v108, v112
  v_add_f32 v109, v109, v113
  v_lshlrev_b32 v112, 16, v71
  v_and_b32 v113, 0xffff0000, v71
  v_add_f32 v110, v110, v112
  v_add_f32 v111, v111, v113
  s_waitcnt vmcnt(2)
  v_lshlrev_b32 v112, 16, v72
  v_and_b32 v113, 0xffff0000, v72
  v_add_f32 v96, v96, v112
  v_add_f32 v97, v97, v113
  v_lshlrev_b32 v112, 16, v73
  v_and_b32 v113, 0xffff0000, v73
  v_add_f32 v98, v98, v112
  v_add_f32 v99, v99, v113
  v_lshlrev_b32 v112, 16, v74
  v_and_b32 v113, 0xffff0000, v74
  v_add_f32 v100, v100, v112
  v_add_f32 v101, v101, v113
  v_lshlrev_b32 v112, 16, v75
  v_and_b32 v113, 0xffff0000, v75
  v_add_f32 v102, v102, v112
  v_add_f32 v103, v103, v113
  v_lshlrev_b32 v112, 16, v76
  v_and_b32 v113, 0xffff0000, v76
  v_add_f32 v104, v104, v112
  v_add_f32 v105, v105, v113
  v_lshlrev_b32 v112, 16, v77
  v_and_b32 v113, 0xffff0000, v77
  v_add_f32 v106, v106, v112
  v_add_f32 v107, v107, v113
  v_lshlrev_b32 v112, 16, v78
  v_and_b32 v113, 0xffff0000, v78
  v_add_f32 v108, v108, v112
  v_add_f32 v109, v109, v113
  v_lshlrev_b32 v112, 16, v79
  v_and_b32 v113, 0xffff0000, v79
  v_add_f32 v110, v110, v112
  v_add_f32 v111, v111, v113
  s_waitcnt vmcnt(0)
  v_lshlrev_b32 v112, 16, v80
  v_and_b32 v113, 0xffff0000, v80
  v_add_f32 v96, v96, v112
  v_add_f32 v97, v97, v113
  v_lshlrev_b32 v112, 16, v81
  v_and_b32 v113, 0xffff0000, v81
  v_add_f32 v98, v98, v112
  v_add_f32 v99, v99, v113
  v_lshlrev_b32 v112, 16, v82
  v_and_b32 v113, 0xffff0000, v82
  v_add_f32 v100, v100, v112
  v_add_f32 v101, v101, v113
  v_lshlrev_b32 v112, 16, v83
  v_and_b32 v113, 0xffff0000, v83
  v_add_f32 v102, v102, v112
  v_add_f32 v103, v103, v113
  v_lshlrev_b32 v112, 16, v84
  v_and_b32 v113, 0xffff0000, v84
  v_add_f32 v104, v104, v112
  v_add_f32 v105, v105, v113
  v_lshlrev_b32 v112, 16, v85
  v_and_b32 v113, 0xffff0000, v85
  v_add_f32 v106, v106, v112
  v_add_f32 v107, v107, v113
  v_lshlrev_b32 v112, 16, v86
  v_and_b32 v113, 0xffff0000, v86
  v_add_f32 v108, v108, v112
  v_add_f32 v109, v109, v113
  v_lshlrev_b32 v112, 16, v87
  v_and_b32 v113, 0xffff0000, v87
  v_add_f32 v110, v110, v112
  v_add_f32 v111, v111, v113
  v_cvt_pk_bf16_f32 v64, v96, v97
  v_cvt_pk_bf16_f32 v65, v98, v99
  v_cvt_pk_bf16_f32 v66, v100, v101
  v_cvt_pk_bf16_f32 v67, v102, v103
  v_cvt_pk_bf16_f32 v68, v104, v105
  v_cvt_pk_bf16_f32 v69, v106, v107
  v_cvt_pk_bf16_f32 v70, v108, v109
  v_cvt_pk_bf16_f32 v71, v110, v111
  buffer_store_dwordx4 v[64:67], v128, s[16:19], s35 offen nt
  buffer_store_dwordx4 v[68:71], v128, s[16:19], s35 offen offset:32 nt
concat_heads__gqa_block_cached__gqa_block_cached__near_ridge_kernel_odone:
  s_branch concat_heads__gqa_block_cached__gqa_block_cached__near_ridge_kernel_end
concat_heads__gqa_block_cached__gqa_block_cached__near_ridge_kernel_awo:
  s_cmp_eq_u32 s39, 12
  s_cbranch_scc0 concat_heads__gqa_block_cached__gqa_block_cached__near_ridge_kernel_awo13
  s_lshl_b32 s35, s44, 17
  s_lshl_b32 s36, s32, 2
  s_add_u32 s35, s35, s36
  s_add_u32 m0, s32, 32768
  s_add_u32 s38, s35, 0
  buffer_load_dwordx4 v159, s[8:11], s38 offen nt lds
  s_add_u32 m0, s32, 36864
  s_add_u32 s38, s35, 16384
  buffer_load_dwordx4 v159, s[8:11], s38 offen nt lds
  s_add_u32 m0, s32, 40960
  s_add_u32 s38, s35, 131072
  buffer_load_dwordx4 v159, s[8:11], s38 offen nt lds
  s_add_u32 m0, s32, 45056
  s_add_u32 s38, s35, 147456
  buffer_load_dwordx4 v159, s[8:11], s38 offen nt lds
  s_lshl_b32 s35, s44, 17
  s_lshl_b32 s36, s32, 2
  s_add_u32 s35, s35, s36
  s_add_u32 m0, s32, 49152
  s_add_u32 s38, s35, 32768
  buffer_load_dwordx4 v159, s[8:11], s38 offen nt lds
  s_add_u32 m0, s32, 53248
  s_add_u32 s38, s35, 49152
  buffer_load_dwordx4 v159, s[8:11], s38 offen nt lds
  s_add_u32 m0, s32, 57344
  s_add_u32 s38, s35, 163840
  buffer_load_dwordx4 v159, s[8:11], s38 offen nt lds
  s_add_u32 m0, s32, 61440
  s_add_u32 s38, s35, 180224
  buffer_load_dwordx4 v159, s[8:11], s38 offen nt lds
  s_branch concat_heads__gqa_block_cached__gqa_block_cached__near_ridge_kernel_afilled
concat_heads__gqa_block_cached__gqa_block_cached__near_ridge_kernel_awo13:
  s_lshl_b32 s35, s44, 17
  s_lshl_b32 s36, s32, 2
  s_add_u32 s35, s35, s36
  s_add_u32 m0, s32, 65536
  s_add_u32 s38, s35, 65536
  buffer_load_dwordx4 v159, s[8:11], s38 offen nt lds
  s_add_u32 m0, s32, 69632
  s_add_u32 s38, s35, 81920
  buffer_load_dwordx4 v159, s[8:11], s38 offen nt lds
  s_add_u32 m0, s32, 73728
  s_add_u32 s38, s35, 196608
  buffer_load_dwordx4 v159, s[8:11], s38 offen nt lds
  s_add_u32 m0, s32, 77824
  s_add_u32 s38, s35, 212992
  buffer_load_dwordx4 v159, s[8:11], s38 offen nt lds
  s_branch concat_heads__gqa_block_cached__gqa_block_cached__near_ridge_kernel_afilled
concat_heads__gqa_block_cached__gqa_block_cached__near_ridge_kernel_wtl:
  s_cmp_eq_u32 s30, 2
  s_cbranch_scc0 concat_heads__gqa_block_cached__gqa_block_cached__near_ridge_kernel_c2_17
  s_lshr_b32 s35, s44, 3
  s_lshl_b32 s35, s35, 20
  s_lshl_b32 s36, s46, 2
  s_add_u32 s36, s36, s100
  s_lshl_b32 s36, s36, 15
  s_add_u32 s35, s35, s36
  s_lshl_b32 s36, s29, 14
  s_add_u32 s35, s35, s36
  s_lshl_b32 s36, s100, 8
  s_sub_u32 s35, s35, s36
  v_lshlrev_b32 v154, 7, v162
  s_add_u32 s36, s35, 0
  buffer_load_dword v163, v154, s[8:11], s36 offen
  s_add_u32 s36, s35, 8192
  buffer_load_dword v164, v154, s[8:11], s36 offen
concat_heads__gqa_block_cached__gqa_block_cached__near_ridge_kernel_c2_17:
  s_branch concat_heads__gqa_block_cached__gqa_block_cached__near_ridge_kernel_wtb
concat_heads__gqa_block_cached__gqa_block_cached__near_ridge_kernel_atailw:
  s_cmp_eq_u32 s39, 13
  s_cbranch_scc0 concat_heads__gqa_block_cached__gqa_block_cached__near_ridge_kernel_tw18
  s_waitcnt vmcnt(16)
  s_branch concat_heads__gqa_block_cached__gqa_block_cached__near_ridge_kernel_atailb
concat_heads__gqa_block_cached__gqa_block_cached__near_ridge_kernel_tw18:
  s_waitcnt vmcnt(12)
  s_branch concat_heads__gqa_block_cached__gqa_block_cached__near_ridge_kernel_atailb
concat_heads__gqa_block_cached__gqa_block_cached__near_ridge_kernel_rare_lp0:
  v_mov_b32 v153, v152
  s_nop 1
  v_permlane32_swap_b32 v152, v153
  s_nop 0
  v_max_f32 v152, v152, v153
  v_max_f32 v152, 0, v152
  v_sub_f32 v153, 0, v152
  v_exp_f32 v153, v153
  v_sub_f32 v96, v96, v152
  v_sub_f32 v97, v97, v152
  v_sub_f32 v98, v98, v152
  v_sub_f32 v99, v99, v152
  v_sub_f32 v100, v100, v152
  v_sub_f32 v101, v101, v152
  v_sub_f32 v102, v102, v152
  v_sub_f32 v103, v103, v152
  v_sub_f32 v104, v104, v152
  v_sub_f32 v105, v105, v152
  v_sub_f32 v106, v106, v152
  v_sub_f32 v107, v107, v152
  v_sub_f32 v108, v108, v152
  v_sub_f32 v109, v109, v152
  v_sub_f32 v110, v110, v152
  v_sub_f32 v111, v111, v152
  v_sub_f32 v112, v112, v152
  v_sub_f32 v113, v113, v152
  v_sub_f32 v114, v114, v152
  v_sub_f32 v115, v115, v152
  v_sub_f32 v116, v116, v152
  v_sub_f32 v117, v117, v152
  v_sub_f32 v118, v118, v152
  v_sub_f32 v119, v119, v152
  v_sub_f32 v120, v120, v152
  v_sub_f32 v121, v121, v152
  v_sub_f32 v122, v122, v152
  v_sub_f32 v123, v123, v152
  v_sub_f32 v124, v124, v152
  v_sub_f32 v125, v125, v152
  v_sub_f32 v126, v126, v152
  v_sub_f32 v127, v127, v152
  v_mul_f32 v0, v0, v153
  v_mul_f32 v1, v1, v153
  v_mul_f32 v2, v2, v153
  v_mul_f32 v3, v3, v153
  v_mul_f32 v4, v4, v153
  v_mul_f32 v5, v5, v153
  v_mul_f32 v6, v6, v153
  v_mul_f32 v7, v7, v153
  v_mul_f32 v8, v8, v153
  v_mul_f32 v9, v9, v153
  v_mul_f32 v10, v10, v153
  v_mul_f32 v11, v11, v153
  v_mul_f32 v12, v12, v153
  v_mul_f32 v13, v13, v153
  v_mul_f32 v14, v14, v153
  v_mul_f32 v15, v15, v153
  v_mul_f32 v16, v16, v153
  v_mul_f32 v17, v17, v153
  v_mul_f32 v18, v18, v153
  v_mul_f32 v19, v19, v153
  v_mul_f32 v20, v20, v153
  v_mul_f32 v21, v21, v153
  v_mul_f32 v22, v22, v153
  v_mul_f32 v23, v23, v153
  v_mul_f32 v24, v24, v153
  v_mul_f32 v25, v25, v153
  v_mul_f32 v26, v26, v153
  v_mul_f32 v27, v27, v153
  v_mul_f32 v28, v28, v153
  v_mul_f32 v29, v29, v153
  v_mul_f32 v30, v30, v153
  v_mul_f32 v31, v31, v153
  v_mul_f32 v32, v32, v153
  v_mul_f32 v33, v33, v153
  v_mul_f32 v34, v34, v153
  v_mul_f32 v35, v35, v153
  v_mul_f32 v36, v36, v153
  v_mul_f32 v37, v37, v153
  v_mul_f32 v38, v38, v153
  v_mul_f32 v39, v39, v153
  v_mul_f32 v40, v40, v153
  v_mul_f32 v41, v41, v153
  v_mul_f32 v42, v42, v153
  v_mul_f32 v43, v43, v153
  v_mul_f32 v44, v44, v153
  v_mul_f32 v45, v45, v153
  v_mul_f32 v46, v46, v153
  v_mul_f32 v47, v47, v153
  v_mul_f32 v48, v48, v153
  v_mul_f32 v49, v49, v153
  v_mul_f32 v50, v50, v153
  v_mul_f32 v51, v51, v153
  v_mul_f32 v52, v52, v153
  v_mul_f32 v53, v53, v153
  v_mul_f32 v54, v54, v153
  v_mul_f32 v55, v55, v153
  v_mul_f32 v56, v56, v153
  v_mul_f32 v57, v57, v153
  v_mul_f32 v58, v58, v153
  v_mul_f32 v59, v59, v153
  v_mul_f32 v60, v60, v153
  v_mul_f32 v61, v61, v153
  v_mul_f32 v62, v62, v153
  v_mul_f32 v63, v63, v153
  v_mul_f32 v150, v150, v153
  v_mul_f32 v151, v151, v153
  s_branch concat_heads__gqa_block_cached__gqa_block_cached__near_ridge_kernel_back_lp0
concat_heads__gqa_block_cached__gqa_block_cached__near_ridge_kernel_rare_lp1:
  v_mov_b32 v153, v152
  s_nop 1
  v_permlane32_swap_b32 v152, v153
  s_nop 0
  v_max_f32 v152, v152, v153
  v_max_f32 v152, 0, v152
  v_sub_f32 v153, 0, v152
  v_exp_f32 v153, v153
  v_sub_f32 v96, v96, v152
  v_sub_f32 v97, v97, v152
  v_sub_f32 v98, v98, v152
  v_sub_f32 v99, v99, v152
  v_sub_f32 v100, v100, v152
  v_sub_f32 v101, v101, v152
  v_sub_f32 v102, v102, v152
  v_sub_f32 v103, v103, v152
  v_sub_f32 v104, v104, v152
  v_sub_f32 v105, v105, v152
  v_sub_f32 v106, v106, v152
  v_sub_f32 v107, v107, v152
  v_sub_f32 v108, v108, v152
  v_sub_f32 v109, v109, v152
  v_sub_f32 v110, v110, v152
  v_sub_f32 v111, v111, v152
  v_sub_f32 v112, v112, v152
  v_sub_f32 v113, v113, v152
  v_sub_f32 v114, v114, v152
  v_sub_f32 v115, v115, v152
  v_sub_f32 v116, v116, v152
  v_sub_f32 v117, v117, v152
  v_sub_f32 v118, v118, v152
  v_sub_f32 v119, v119, v152
  v_sub_f32 v120, v120, v152
  v_sub_f32 v121, v121, v152
  v_sub_f32 v122, v122, v152
  v_sub_f32 v123, v123, v152
  v_sub_f32 v124, v124, v152
  v_sub_f32 v125, v125, v152
  v_sub_f32 v126, v126, v152
  v_sub_f32 v127, v127, v152
  v_mul_f32 v0, v0, v153
  v_mul_f32 v1, v1, v153
  v_mul_f32 v2, v2, v153
  v_mul_f32 v3, v3, v153
  v_mul_f32 v4, v4, v153
  v_mul_f32 v5, v5, v153
  v_mul_f32 v6, v6, v153
  v_mul_f32 v7, v7, v153
  v_mul_f32 v8, v8, v153
  v_mul_f32 v9, v9, v153
  v_mul_f32 v10, v10, v153
  v_mul_f32 v11, v11, v153
  v_mul_f32 v12, v12, v153
  v_mul_f32 v13, v13, v153
  v_mul_f32 v14, v14, v153
  v_mul_f32 v15, v15, v153
  v_mul_f32 v16, v16, v153
  v_mul_f32 v17, v17, v153
  v_mul_f32 v18, v18, v153
  v_mul_f32 v19, v19, v153
  v_mul_f32 v20, v20, v153
  v_mul_f32 v21, v21, v153
  v_mul_f32 v22, v22, v153
  v_mul_f32 v23, v23, v153
  v_mul_f32 v24, v24, v153
  v_mul_f32 v25, v25, v153
  v_mul_f32 v26, v26, v153
  v_mul_f32 v27, v27, v153
  v_mul_f32 v28, v28, v153
  v_mul_f32 v29, v29, v153
  v_mul_f32 v30, v30, v153
  v_mul_f32 v31, v31, v153
  v_mul_f32 v32, v32, v153
  v_mul_f32 v33, v33, v153
  v_mul_f32 v34, v34, v153
  v_mul_f32 v35, v35, v153
  v_mul_f32 v36, v36, v153
  v_mul_f32 v37, v37, v153
  v_mul_f32 v38, v38, v153
  v_mul_f32 v39, v39, v153
  v_mul_f32 v40, v40, v153
  v_mul_f32 v41, v41, v153
  v_mul_f32 v42, v42, v153
  v_mul_f32 v43, v43, v153
  v_mul_f32 v44, v44, v153
  v_mul_f32 v45, v45, v153
  v_mul_f32 v46, v46, v153
  v_mul_f32 v47, v47, v153
  v_mul_f32 v48, v48, v153
  v_mul_f32 v49, v49, v153
  v_mul_f32 v50, v50, v153
  v_mul_f32 v51, v51, v153
  v_mul_f32 v52, v52, v153
  v_mul_f32 v53, v53, v153
  v_mul_f32 v54, v54, v153
  v_mul_f32 v55, v55, v153
  v_mul_f32 v56, v56, v153
  v_mul_f32 v57, v57, v153
  v_mul_f32 v58, v58, v153
  v_mul_f32 v59, v59, v153
  v_mul_f32 v60, v60, v153
  v_mul_f32 v61, v61, v153
  v_mul_f32 v62, v62, v153
  v_mul_f32 v63, v63, v153
  v_mul_f32 v150, v150, v153
  v_mul_f32 v151, v151, v153
  s_branch concat_heads__gqa_block_cached__gqa_block_cached__near_ridge_kernel_back_lp1
concat_heads__gqa_block_cached__gqa_block_cached__near_ridge_kernel_rare_t15:
  v_mov_b32 v153, v152
  s_nop 1
  v_permlane32_swap_b32 v152, v153
  s_nop 0
  v_max_f32 v152, v152, v153
  v_max_f32 v152, 0, v152
  v_sub_f32 v153, 0, v152
  v_exp_f32 v153, v153
  v_sub_f32 v96, v96, v152
  v_sub_f32 v97, v97, v152
  v_sub_f32 v98, v98, v152
  v_sub_f32 v99, v99, v152
  v_sub_f32 v100, v100, v152
  v_sub_f32 v101, v101, v152
  v_sub_f32 v102, v102, v152
  v_sub_f32 v103, v103, v152
  v_sub_f32 v104, v104, v152
  v_sub_f32 v105, v105, v152
  v_sub_f32 v106, v106, v152
  v_sub_f32 v107, v107, v152
  v_sub_f32 v108, v108, v152
  v_sub_f32 v109, v109, v152
  v_sub_f32 v110, v110, v152
  v_sub_f32 v111, v111, v152
  v_sub_f32 v112, v112, v152
  v_sub_f32 v113, v113, v152
  v_sub_f32 v114, v114, v152
  v_sub_f32 v115, v115, v152
  v_sub_f32 v116, v116, v152
  v_sub_f32 v117, v117, v152
  v_sub_f32 v118, v118, v152
  v_sub_f32 v119, v119, v152
  v_sub_f32 v120, v120, v152
  v_sub_f32 v121, v121, v152
  v_sub_f32 v122, v122, v152
  v_sub_f32 v123, v123, v152
  v_sub_f32 v124, v124, v152
  v_sub_f32 v125, v125, v152
  v_sub_f32 v126, v126, v152
  v_sub_f32 v127, v127, v152
  v_mul_f32 v0, v0, v153
  v_mul_f32 v1, v1, v153
  v_mul_f32 v2, v2, v153
  v_mul_f32 v3, v3, v153
  v_mul_f32 v4, v4, v153
  v_mul_f32 v5, v5, v153
  v_mul_f32 v6, v6, v153
  v_mul_f32 v7, v7, v153
  v_mul_f32 v8, v8, v153
  v_mul_f32 v9, v9, v153
  v_mul_f32 v10, v10, v153
  v_mul_f32 v11, v11, v153
  v_mul_f32 v12, v12, v153
  v_mul_f32 v13, v13, v153
  v_mul_f32 v14, v14, v153
  v_mul_f32 v15, v15, v153
  v_mul_f32 v16, v16, v153
  v_mul_f32 v17, v17, v153
  v_mul_f32 v18, v18, v153
  v_mul_f32 v19, v19, v153
  v_mul_f32 v20, v20, v153
  v_mul_f32 v21, v21, v153
  v_mul_f32 v22, v22, v153
  v_mul_f32 v23, v23, v153
  v_mul_f32 v24, v24, v153
  v_mul_f32 v25, v25, v153
  v_mul_f32 v26, v26, v153
  v_mul_f32 v27, v27, v153
  v_mul_f32 v28, v28, v153
  v_mul_f32 v29, v29, v153
  v_mul_f32 v30, v30, v153
  v_mul_f32 v31, v31, v153
  v_mul_f32 v32, v32, v153
  v_mul_f32 v33, v33, v153
  v_mul_f32 v34, v34, v153
  v_mul_f32 v35, v35, v153
  v_mul_f32 v36, v36, v153
  v_mul_f32 v37, v37, v153
  v_mul_f32 v38, v38, v153
  v_mul_f32 v39, v39, v153
  v_mul_f32 v40, v40, v153
  v_mul_f32 v41, v41, v153
  v_mul_f32 v42, v42, v153
  v_mul_f32 v43, v43, v153
  v_mul_f32 v44, v44, v153
  v_mul_f32 v45, v45, v153
  v_mul_f32 v46, v46, v153
  v_mul_f32 v47, v47, v153
  v_mul_f32 v48, v48, v153
  v_mul_f32 v49, v49, v153
  v_mul_f32 v50, v50, v153
  v_mul_f32 v51, v51, v153
  v_mul_f32 v52, v52, v153
  v_mul_f32 v53, v53, v153
  v_mul_f32 v54, v54, v153
  v_mul_f32 v55, v55, v153
  v_mul_f32 v56, v56, v153
  v_mul_f32 v57, v57, v153
  v_mul_f32 v58, v58, v153
  v_mul_f32 v59, v59, v153
  v_mul_f32 v60, v60, v153
  v_mul_f32 v61, v61, v153
  v_mul_f32 v62, v62, v153
  v_mul_f32 v63, v63, v153
  v_mul_f32 v150, v150, v153
  v_mul_f32 v151, v151, v153
  s_branch concat_heads__gqa_block_cached__gqa_block_cached__near_ridge_kernel_back_t15
concat_heads__gqa_block_cached__gqa_block_cached__near_ridge_kernel_end:
  s_endpgm
.section .rodata,"a"
.p2align 6
.amdhsa_kernel concat_heads__gqa_block_cached__gqa_block_cached__near_ridge_kernel
  .amdhsa_next_free_vgpr 168
  .amdhsa_next_free_sgpr 102
  .amdhsa_accum_offset 168
  .amdhsa_group_segment_fixed_size 0
  .amdhsa_kernarg_size 104
  .amdhsa_user_sgpr_count 2
  .amdhsa_user_sgpr_kernarg_segment_ptr 1
  .amdhsa_system_sgpr_workgroup_id_x 1
  .amdhsa_float_denorm_mode_32 3
.end_amdhsa_kernel
.text
```
